```python
import torch

def _softmax(x, axis=-1):
    return torch.softmax(x, dim=axis)
def _gelu(x):
    return torch.nn.functional.gelu(x, approximate="tanh")
def _silu(x):
    return torch.nn.functional.silu(x)
def _sigmoid(x):
    return torch.sigmoid(x)
def _layernorm(x, axis=-1, eps=1e-5):
    m = x.mean(dim=axis, keepdim=True)
    v = x.var(dim=axis, keepdim=True, unbiased=False)
    return (x - m) / torch.sqrt(v + eps)
def _scatter_add(tgt, idx, src, axis=0):
    return tgt.clone().index_add_(axis, idx, src)
def _segment_sum(src, seg, n):
    out = torch.zeros((n,) + src.shape[1:], dtype=src.dtype)
    return out.index_add_(0, seg, src)
def _pad(x, pw):
    flat = tuple(v for pair in reversed(pw) for v in pair)
    return torch.nn.functional.pad(x, flat)

kernel_name = 'parallel_sum__sliding_block_cached__glu_gated_bilinear__decode'

def setup_inputs():

    _w = (lambda a: (lambda t: t.to(torch.bfloat16) if t.is_floating_point() else t)(torch.as_tensor(a)))
    def _A_setup():
        B, Sq, D = 4, 1, 1024
        Hq, Hkv, Sk, Dh = 32, 4, 8192, 128
        assert Hq % Hkv == 0, (Hq, Hkv)
        return {
            "x": _w((lambda *s: torch.randn(*s, dtype=torch.bfloat16) * 0.05)(B, Sq, D)),
            "k_cache": _w((lambda *s: torch.randn(*s, dtype=torch.bfloat16) * 1.6)(B, Hkv, Sk, Dh)),
            "v_cache": _w((lambda *s: torch.randn(*s, dtype=torch.bfloat16) * 0.8)(B, Hkv, Sk, Dh)),
            "wq": _w((lambda *s: torch.randn(*s, dtype=torch.bfloat16) * 1.6)(D, Hq * Dh) * (D ** -0.5)),
            "wo": _w((lambda *s: torch.randn(*s, dtype=torch.bfloat16) * 0.8)(Hq * Dh, D) * ((Hq * Dh) ** -0.5)),
        }
    _A_in = _A_setup()

    def _B_setup():
        B, S, D, F = 4, 1, 1024, 3584
        return {
            "x": _w((lambda *s: torch.randn(*s, dtype=torch.bfloat16) * 0.05)(B, S, D)),
            "w_gate": _w((lambda *s: torch.randn(*s, dtype=torch.bfloat16) * 0.4)(D, F) * (D ** -0.5)),
            "w_up": _w((lambda *s: torch.randn(*s, dtype=torch.bfloat16) * 0.4)(D, F) * (D ** -0.5)),
            "w_down": _w((lambda *s: torch.randn(*s, dtype=torch.bfloat16) * 0.4)(F, D) * (F ** -0.5)),
        }
    _B_in = _B_setup()

    return {
        "A_x": _A_in["x"],
        "A_k_cache": _A_in["k_cache"],
        "A_v_cache": _A_in["v_cache"],
        "A_wq": _A_in["wq"],
        "A_wo": _A_in["wo"],
        "B_x": _B_in["x"],
        "B_w_gate": _B_in["w_gate"],
        "B_w_up": _B_in["w_up"],
        "B_w_down": _B_in["w_down"],
    }

def reference(A_x, A_k_cache, A_v_cache, A_wq, A_wo, B_x, B_w_gate, B_w_up, B_w_down):
    def _A_ref(x, k_cache, v_cache, wq, wo):
        B, Sq, D = x.shape
        Hq, Dh = 32, 128
        Hkv, Sk = k_cache.shape[1], k_cache.shape[2]
        W = min(4096, max(256, Sk // 4))
        rep = Hq // Hkv
        q = (lambda x, *d: x.permute(*d))((x @ wq).reshape(B, Sq, Hq, Dh), 0, 2, 1, 3)
        k = (lambda x, n, axis: torch.repeat_interleave(x, n, dim=axis))(k_cache[:, :, Sk - W:, :], rep, axis=1)
        v = (lambda x, n, axis: torch.repeat_interleave(x, n, dim=axis))(v_cache[:, :, Sk - W:, :], rep, axis=1)
        scores = torch.einsum("bhqd,bhkd->bhqk", q, k) * (Dh ** -0.5)
        p = _softmax(scores, axis=-1)
        o = torch.einsum("bhqk,bhkd->bhqd", p, v)
        return (lambda x, *d: x.permute(*d))(o, 0, 2, 1, 3).reshape(B, Sq, Hq * Dh) @ wo

    def _B_ref(x, w_gate, w_up, w_down):
        g = torch.einsum("bsd,df->bsf", x, w_gate)
        u = torch.einsum("bsd,df->bsf", x, w_up)
        h = g * u
        return torch.einsum("bsf,fd->bsd", h, w_down)

    x = A_x
    xn = _layernorm(x, axis=-1)
    return x + _A_ref(xn, A_k_cache, A_v_cache, A_wq, A_wo) + _B_ref(xn, B_w_gate, B_w_up, B_w_down)
```

```asm
; @launch grid=(256,1,1) block=(512,1,1) lds=79360
.amdgcn_target "amdgcn-amd-amdhsa--gfx950"
.text
.globl parallel_sum__sliding_block_cached__glu_gated_bilinear__decode_kernel
.p2align 8
.type parallel_sum__sliding_block_cached__glu_gated_bilinear__decode_kernel,@function
parallel_sum__sliding_block_cached__glu_gated_bilinear__decode_kernel:
    s_cmp_ge_u32 s2, 256
    s_cbranch_scc1 L_end
    s_load_dwordx16 s[4:19], s[0:1], 0
    s_load_dwordx8 s[20:27], s[0:1], 64
    s_cmp_ge_u32 s2, 256
    s_cbranch_scc1 Lnopf_1
    s_getpc_b64 s[96:97]
L_pc:
    s_sub_u32 s96, s96, L_pc-parallel_sum__sliding_block_cached__glu_gated_bilinear__decode_kernel
    s_subb_u32 s97, s97, 0
    v_lshlrev_b32 v46, 4, v0
    v_min_u32 v47, L_codeend-parallel_sum__sliding_block_cached__glu_gated_bilinear__decode_kernel-16, v46
    global_load_dwordx4 v[132:135], v47, s[96:97]
    v_add_u32 v46, 0x2000, v46
    v_min_u32 v47, L_codeend-parallel_sum__sliding_block_cached__glu_gated_bilinear__decode_kernel-16, v46
    global_load_dwordx4 v[136:139], v47, s[96:97]
    s_nop 0
Lnopf_1:
    v_lshrrev_b32 v45, 6, v0
    v_and_b32 v1, 63, v0
    v_readfirstlane_b32 s3, v45
    v_and_b32 v2, 15, v1
    v_lshrrev_b32 v3, 4, v1
    v_lshlrev_b32 v21, 4, v2
    v_lshlrev_b32 v20, 4, v1
    v_lshl_add_u32 v7, v3, 15, v21
    s_and_b32 s76, s2, 7
    s_lshl3_add_u32 s76, s76, s3
    s_lshl_b32 s72, s76, 17
    s_lshr_b32 s77, s2, 3
    s_lshl_b32 s77, s77, 8
    s_add_u32 s72, s72, s77
    s_lshl_b32 s78, s3, 11
    s_cmp_ge_u32 s3, 4
    s_waitcnt lgkmcnt(0)
    s_mov_b32 s28, s4
    s_mov_b32 s29, s5
    s_mov_b32 s30, 8192
    s_mov_b32 s31, 0x00020000
    s_cbranch_scc1 L_nox
    buffer_load_dwordx4 v[148:151], v20, s[28:31], s78 offen
    buffer_load_dwordx4 v[152:155], v20, s[28:31], s78 offen offset:1024
L_nox:
    s_mov_b32 s40, s10
    s_mov_b32 s41, s11
    s_mov_b32 s42, 8388608
    s_mov_b32 s43, 0x00020000
    buffer_load_dwordx4 v[52:55], v7, s[40:43], s72 offen nt
    s_add_u32 s96, s72, 8192
    buffer_load_dwordx4 v[56:59], v7, s[40:43], s96 offen nt
    s_add_u32 s96, s72, 16384
    buffer_load_dwordx4 v[60:63], v7, s[40:43], s96 offen nt
    s_add_u32 s96, s72, 24576
    buffer_load_dwordx4 v[64:67], v7, s[40:43], s96 offen nt
    s_mov_b32 s60, s26
    s_mov_b32 s61, s27
    s_mov_b32 s62, 268435456
    s_mov_b32 s63, 0x00020000
    s_load_dword s64, s[26:27], 0
    s_lshl_b32 s90, s2, 5
    v_and_b32 v45, 3, v1
    v_lshlrev_b32 v41, 3, v45
    v_lshl_add_u32 v41, v3, 1, v41
    buffer_load_ushort v44, v41, s[28:31], s90 offen
    s_cmp_ge_u32 s2, 224
    s_cbranch_scc1 L_nogu
    s_lshl_b32 s76, s76, 6
    v_lshrrev_b32 v45, 2, v2
    v_mul_u32_u24 v46, 4160, v45
    v_lshl_add_u32 v15, v3, 4, v46
    v_add_u32 v15, s76, v15
    s_lshr_b32 s95, s3, 1
    s_and_b32 s97, s3, 1
    v_lshl_add_u32 v16, v3, 5, v46
    s_lshr_b32 s78, s2, 3
    s_add_u32 s78, s78, 1
    s_sub_u32 s96, s78, 28
    s_min_u32 s78, s78, s96
    s_bfe_u32 s79, s2, 0x10002
    s_cselect_b32 s48, s18, s16
    s_cselect_b32 s49, s19, s17
    s_mov_b32 s50, 7340032
    s_mov_b32 s51, 0x00020000
    s_and_b32 s76, s2, 3
    s_lshl3_add_u32 s77, s76, s3
    s_mul_i32 s74, s77, 229376
    s_lshl_b32 s96, s78, 8
    s_lshl_b32 s77, s77, 7
    v_add_u32 v16, s77, v16
    v_mul_u32_u24 v8, 0xe000, v3
    s_add_u32 s74, s74, s96
    v_add_u32 v8, v8, v21
    s_lshl1_add_u32 s96, s78, s97
    s_lshl2_add_u32 s96, s96, s95
    s_lshl1_add_u32 s96, s96, s79
    s_lshl2_add_u32 s96, s96, s76
    s_lshl_b32 s84, s96, 8
    s_add_u32 s84, s84, 4194304
    s_and_b32 s76, s2, 7
    s_lshr_b32 s77, s2, 7
    s_lshl3_add_u32 s76, s77, s76
    s_bfe_u32 s77, s2, 0x40003
    s_lshl_b32 s73, s76, 9
    s_lshl3_add_u32 s96, s77, s3
    s_add_u32 s73, s73, s96
    s_add_u32 s73, s73, 384
    s_lshl_b32 s73, s73, 12
    v_xor_b32 v47, v2, v3
    v_lshlrev_b32 v47, 4, v47
    v_lshl_add_u32 v11, v3, 8, v47
    v_xor_b32 v12, 64, v11
    v_xor_b32 v13, 0x80, v11
    v_xor_b32 v14, 0xc0, v11
    s_mov_b32 s32, s6
    s_mov_b32 s33, s7
    s_mov_b32 s34, 33554432
    s_mov_b32 s35, 0x00020000
    s_mov_b32 s36, s8
    s_mov_b32 s37, s9
    s_mov_b32 s38, 33554432
    s_mov_b32 s39, 0x00020000
    s_lshl_b32 s91, s3, 12
    s_add_u32 s91, s91, 46592
    s_mov_b32 m0, s91
    v_lshl_add_u32 v10, v3, 10, v21
    v_lshl_add_u32 v23, v2, 8, v47
    v_add_u32 v23, s91, v23
    v_and_b32 v45, 3, v1
    v_and_b32 v46, 1, v1
    v_lshlrev_b32 v46, 4, v46
    v_mov_b32 v47, 0xffff
    v_lshlrev_b32 v47, v46, v47
    v_cmp_gt_u32 vcc, 2, v45
    v_mov_b32 v6, 0xff
    s_nop 0
    v_cndmask_b32 v4, 0, v47, vcc
    v_cndmask_b32 v5, v47, 0, vcc
    s_lshl_b32 s78, s3, 11
    s_add_u32 s78, s78, 30208
    v_lshlrev_b32 v48, 5, v2
    v_lshl_add_u32 v48, v3, 9, v48
    v_add_u32 v17, s78, v48
    v_add_u32 v32, s91, v48
    s_lshl_b32 s78, s3, 8
    s_add_u32 s78, s78, 30208
    v_add_u32 v18, s78, v21
    s_lshl_b32 s78, s95, 8
    s_add_u32 s78, s78, s2
    s_lshl1_add_u32 s78, s78, s97
    s_lshl_b32 s80, s78, 8
    s_add_u32 s80, s80, 1048576
    buffer_load_dwordx4 v11, s[32:35], s73 offen nt lds
    s_cmp_ge_u32 s3, 4
    s_cbranch_scc1 Ldef_2
    s_mul_i32 s78, s3, 4160
    v_lshlrev_b32 v48, 1, v20
    v_add_u32 v48, s78, v48
    s_waitcnt vmcnt(6)
    v_lshlrev_b32 v212, 16, v148
    v_and_b32 v213, 0xffff0000, v148
    v_lshlrev_b32 v214, 16, v149
    v_and_b32 v215, 0xffff0000, v149
    v_lshlrev_b32 v216, 16, v150
    v_and_b32 v217, 0xffff0000, v150
    v_lshlrev_b32 v218, 16, v151
    v_and_b32 v219, 0xffff0000, v151
    v_lshlrev_b32 v220, 16, v152
    v_and_b32 v221, 0xffff0000, v152
    v_lshlrev_b32 v222, 16, v153
    v_and_b32 v223, 0xffff0000, v153
    v_lshlrev_b32 v224, 16, v154
    v_and_b32 v225, 0xffff0000, v154
    v_lshlrev_b32 v226, 16, v155
    v_and_b32 v227, 0xffff0000, v155
    v_readfirstlane_b32 s100, v212
    s_nop 1
    v_pk_add_f32 v[156:157], v[212:213], s[100:101] op_sel_hi:[1,0] neg_lo:[0,1] neg_hi:[0,1]
    v_pk_add_f32 v[158:159], v[214:215], s[100:101] op_sel_hi:[1,0] neg_lo:[0,1] neg_hi:[0,1]
    v_pk_add_f32 v[160:161], v[216:217], s[100:101] op_sel_hi:[1,0] neg_lo:[0,1] neg_hi:[0,1]
    v_pk_add_f32 v[162:163], v[218:219], s[100:101] op_sel_hi:[1,0] neg_lo:[0,1] neg_hi:[0,1]
    v_pk_add_f32 v[164:165], v[220:221], s[100:101] op_sel_hi:[1,0] neg_lo:[0,1] neg_hi:[0,1]
    v_pk_add_f32 v[166:167], v[222:223], s[100:101] op_sel_hi:[1,0] neg_lo:[0,1] neg_hi:[0,1]
    v_pk_add_f32 v[168:169], v[224:225], s[100:101] op_sel_hi:[1,0] neg_lo:[0,1] neg_hi:[0,1]
    v_pk_add_f32 v[170:171], v[226:227], s[100:101] op_sel_hi:[1,0] neg_lo:[0,1] neg_hi:[0,1]
    v_pk_add_f32 v[228:229], v[156:157], v[158:159]
    v_pk_add_f32 v[230:231], v[160:161], v[162:163]
    v_pk_add_f32 v[232:233], v[164:165], v[166:167]
    v_pk_add_f32 v[234:235], v[168:169], v[170:171]
    v_pk_mul_f32 v[236:237], v[156:157], v[156:157]
    v_pk_mul_f32 v[238:239], v[158:159], v[158:159]
    v_pk_add_f32 v[228:229], v[228:229], v[230:231]
    v_pk_add_f32 v[232:233], v[232:233], v[234:235]
    v_pk_fma_f32 v[236:237], v[160:161], v[160:161], v[236:237]
    v_pk_fma_f32 v[238:239], v[162:163], v[162:163], v[238:239]
    v_pk_fma_f32 v[236:237], v[164:165], v[164:165], v[236:237]
    v_pk_fma_f32 v[238:239], v[166:167], v[166:167], v[238:239]
    v_pk_fma_f32 v[236:237], v[168:169], v[168:169], v[236:237]
    v_pk_fma_f32 v[238:239], v[170:171], v[170:171], v[238:239]
    v_pk_add_f32 v[228:229], v[228:229], v[232:233]
    v_pk_add_f32 v[236:237], v[236:237], v[238:239]
    v_add_f32 v228, v228, v229
    v_add_f32 v236, v236, v237
    s_nop 0
    v_add_f32_dpp v228, v228, v228 row_ror:8 row_mask:0xf bank_mask:0xf
    v_add_f32_dpp v236, v236, v236 row_ror:8 row_mask:0xf bank_mask:0xf
    s_nop 0
    v_add_f32_dpp v228, v228, v228 row_ror:4 row_mask:0xf bank_mask:0xf
    v_add_f32_dpp v236, v236, v236 row_ror:4 row_mask:0xf bank_mask:0xf
    s_nop 0
    v_add_f32_dpp v228, v228, v228 row_ror:2 row_mask:0xf bank_mask:0xf
    v_add_f32_dpp v236, v236, v236 row_ror:2 row_mask:0xf bank_mask:0xf
    s_nop 0
    v_add_f32_dpp v228, v228, v228 row_ror:1 row_mask:0xf bank_mask:0xf
    v_add_f32_dpp v236, v236, v236 row_ror:1 row_mask:0xf bank_mask:0xf
    s_nop 0
    v_add_f32_dpp v228, v228, v228 row_bcast:15 row_mask:0xa bank_mask:0xf
    v_add_f32_dpp v236, v236, v236 row_bcast:15 row_mask:0xa bank_mask:0xf
    s_nop 0
    v_add_f32_dpp v228, v228, v228 row_bcast:31 row_mask:0xc bank_mask:0xf
    v_add_f32_dpp v236, v236, v236 row_bcast:31 row_mask:0xc bank_mask:0xf
    v_readlane_b32 s78, v228, 63
    v_readlane_b32 s79, v236, 63
    v_mov_b32 v45, 0x3a800000
    v_mul_f32 v46, s78, v45
    v_mul_f32 v232, s79, v45
    v_add_f32 v230, s100, v46
    v_fma_f32 v232, -v46, v46, v232
    v_max_f32 v232, 0, v232
    v_cvt_pk_bf16_f32 v230, v230, v230
    v_and_b32 v230, 0xffff0000, v230
    v_cvt_pk_bf16_f32 v232, v232, v232
    v_and_b32 v232, 0xffff0000, v232
    v_add_f32 v232, 0x3727c5ac, v232
    v_pk_add_f32 v[212:213], v[212:213], v[230:231] op_sel_hi:[1,0] neg_lo:[0,1] neg_hi:[0,1]
    v_pk_add_f32 v[214:215], v[214:215], v[230:231] op_sel_hi:[1,0] neg_lo:[0,1] neg_hi:[0,1]
    v_pk_add_f32 v[216:217], v[216:217], v[230:231] op_sel_hi:[1,0] neg_lo:[0,1] neg_hi:[0,1]
    v_pk_add_f32 v[218:219], v[218:219], v[230:231] op_sel_hi:[1,0] neg_lo:[0,1] neg_hi:[0,1]
    v_pk_add_f32 v[220:221], v[220:221], v[230:231] op_sel_hi:[1,0] neg_lo:[0,1] neg_hi:[0,1]
    v_pk_add_f32 v[222:223], v[222:223], v[230:231] op_sel_hi:[1,0] neg_lo:[0,1] neg_hi:[0,1]
    v_pk_add_f32 v[224:225], v[224:225], v[230:231] op_sel_hi:[1,0] neg_lo:[0,1] neg_hi:[0,1]
    v_pk_add_f32 v[226:227], v[226:227], v[230:231] op_sel_hi:[1,0] neg_lo:[0,1] neg_hi:[0,1]
    v_cvt_pk_bf16_f32 v232, v232, v232
    v_and_b32 v232, 0xffff0000, v232
    v_sqrt_f32 v232, v232
    v_cvt_pk_bf16_f32 v156, v212, v213
    v_cvt_pk_bf16_f32 v157, v214, v215
    v_cvt_pk_bf16_f32 v158, v216, v217
    v_cvt_pk_bf16_f32 v159, v218, v219
    v_cvt_pk_bf16_f32 v160, v220, v221
    v_cvt_pk_bf16_f32 v161, v222, v223
    v_cvt_pk_bf16_f32 v162, v224, v225
    v_cvt_pk_bf16_f32 v163, v226, v227
    v_cvt_pk_bf16_f32 v232, v232, v232
    v_and_b32 v232, 0xffff0000, v232
    v_rcp_f32 v234, v232
    v_lshlrev_b32 v212, 16, v156
    v_and_b32 v213, 0xffff0000, v156
    v_lshlrev_b32 v214, 16, v157
    v_and_b32 v215, 0xffff0000, v157
    v_lshlrev_b32 v216, 16, v158
    v_and_b32 v217, 0xffff0000, v158
    v_lshlrev_b32 v218, 16, v159
    v_and_b32 v219, 0xffff0000, v159
    v_lshlrev_b32 v220, 16, v160
    v_and_b32 v221, 0xffff0000, v160
    v_lshlrev_b32 v222, 16, v161
    v_and_b32 v223, 0xffff0000, v161
    v_lshlrev_b32 v224, 16, v162
    v_and_b32 v225, 0xffff0000, v162
    v_lshlrev_b32 v226, 16, v163
    v_and_b32 v227, 0xffff0000, v163
    v_pk_mul_f32 v[212:213], v[212:213], v[234:235] op_sel_hi:[1,0]
    v_pk_mul_f32 v[214:215], v[214:215], v[234:235] op_sel_hi:[1,0]
    v_pk_mul_f32 v[216:217], v[216:217], v[234:235] op_sel_hi:[1,0]
    v_pk_mul_f32 v[218:219], v[218:219], v[234:235] op_sel_hi:[1,0]
    v_pk_mul_f32 v[220:221], v[220:221], v[234:235] op_sel_hi:[1,0]
    v_pk_mul_f32 v[222:223], v[222:223], v[234:235] op_sel_hi:[1,0]
    v_pk_mul_f32 v[224:225], v[224:225], v[234:235] op_sel_hi:[1,0]
    v_pk_mul_f32 v[226:227], v[226:227], v[234:235] op_sel_hi:[1,0]
    v_cvt_pk_bf16_f32 v156, v212, v212
    v_cvt_pk_bf16_f32 v157, v213, v213
    v_cvt_pk_bf16_f32 v158, v214, v214
    v_cvt_pk_bf16_f32 v159, v215, v215
    ds_write_b128 v48, v[156:159] offset:13568
    v_cvt_pk_bf16_f32 v160, v216, v216
    v_cvt_pk_bf16_f32 v161, v217, v217
    v_cvt_pk_bf16_f32 v162, v218, v218
    v_cvt_pk_bf16_f32 v163, v219, v219
    ds_write_b128 v48, v[160:163] offset:13584
    v_cvt_pk_bf16_f32 v164, v220, v220
    v_cvt_pk_bf16_f32 v165, v221, v221
    v_cvt_pk_bf16_f32 v166, v222, v222
    v_cvt_pk_bf16_f32 v167, v223, v223
    ds_write_b128 v48, v[164:167] offset:15616
    v_cvt_pk_bf16_f32 v168, v224, v224
    v_cvt_pk_bf16_f32 v169, v225, v225
    v_cvt_pk_bf16_f32 v170, v226, v226
    v_cvt_pk_bf16_f32 v171, v227, v227
    ds_write_b128 v48, v[168:171] offset:15632
    s_nop 0
    s_branch Lb1_3
Ldef_2:
    s_mov_b32 s70, 0x0c0c0400
    s_mov_b32 s71, 0x04000c0c
    s_lshl3_add_u32 s78, s76, s3
    s_lshl_b32 s81, s78, 12
    s_add_u32 s81, s81, 1048576
    s_and_b32 s78, s76, 3
    s_lshl3_add_u32 s78, s78, s3
    s_lshr_b32 s79, s76, 2
    s_lshl3_add_u32 s96, s78, s79
    s_lshl4_add_u32 s96, s96, s77
    s_lshl_b32 s82, s96, 8
    s_add_u32 s82, s82, 2097152
    s_lshl2_add_u32 s96, s78, s79
    s_lshl4_add_u32 s96, s96, s77
    s_lshl_b32 s83, s96, 4
    s_add_u32 s83, s83, 3145728
    s_and_b32 s78, s2, 7
    s_lshr_b32 s79, s2, 5
    s_lshl3_add_u32 s78, s79, s78
    s_bfe_u32 s79, s2, 0x20003
    s_bfe_u32 s96, s2, 0x10004
    s_xor_b32 s96, s96, 1
    s_and_b32 s79, s79, 1
    s_lshl1_add_u32 s79, s79, s96
    s_lshl2_add_u32 s76, s78, s95
    s_lshl_b32 s75, s76, 15
    s_lshl1_add_u32 s96, s79, s97
    s_lshl_b32 s96, s96, 8
    s_add_u32 s75, s75, s96
    s_lshl_b32 s77, s97, 7
    s_lshl_b32 s85, s76, 12
    s_add_u32 s85, s85, s77
    s_add_u32 s85, s85, 2097152
    s_lshl_b32 s87, s76, 11
    s_add_u32 s87, s87, s77
    s_add_u32 s87, s87, 4194304
    s_mov_b32 s52, s20
    s_mov_b32 s53, s21
    s_mov_b32 s54, 7340032
    s_mov_b32 s55, 0x00020000
    s_lshr_b32 s96, s78, 1
    s_lshl2_add_u32 s96, s96, s95
    s_lshl_b32 s86, s96, 8
    s_add_u32 s86, s86, 3145728
    s_and_b32 s96, s3, 3
    s_lshl2_add_u32 s96, s79, s96
    s_lshl_b32 s88, s96, 16
    s_lshl_b32 s96, s78, 6
    s_add_u32 s88, s88, s96
    s_add_u32 s88, s88, 5242880
    s_mov_b32 s44, s12
    s_mov_b32 s45, s13
    s_mov_b32 s46, 8388608
    s_mov_b32 s47, 0x00020000
    s_mov_b32 s56, s22
    s_mov_b32 s57, s23
    s_mov_b32 s58, 8192
    s_mov_b32 s59, 0x00020000
    v_lshl_add_u32 v9, v3, 13, v21
    v_and_b32 v22, 31, v1
    v_lshlrev_b32 v22, 4, v22
    v_xor_b32 v24, 64, v23
    v_xor_b32 v25, 0x80, v23
    v_xor_b32 v26, 0xc0, v23
    v_and_b32 v45, 7, v1
    v_mul_u32_u24 v27, 272, v45
    v_lshl_add_u32 v27, v3, 4, v27
    s_mul_i32 s96, s3, 272
    v_lshrrev_b32 v28, 1, v22
    v_lshrrev_b32 v46, 5, v1
    v_lshl_add_u32 v28, v46, 2, v28
    v_add_u32 v28, s96, v28
    s_lshl_b32 s96, s3, 10
    v_lshlrev_b32 v46, 4, v3
    v_lshl_add_u32 v29, v2, 6, v46
    v_add_u32 v29, s96, v29
    v_lshrrev_b32 v47, 2, v2
    v_lshl_add_u32 v30, v47, 6, v46
    v_add_u32 v30, s96, v30
    v_mul_u32_u24 v39, 320, v47
    v_add_u32 v39, v39, v46
    s_lshl_b32 s96, s95, 6
    v_add_u32 v39, s96, v39
    s_lshl_b32 s96, s3, 3
    v_lshlrev_b32 v31, 6, v2
    v_add_u32 v31, s96, v31
    s_lshl_b32 s96, s3, 6
    v_lshlrev_b32 v33, 3, v45
    v_add_u32 v33, s96, v33
    s_lshl_b32 s96, s3, 9
    s_add_u32 s96, s96, 46592
    v_add_u32 v34, s96, v22
    v_and_b32 v35, 16, v1
    v_lshl_add_u32 v35, v35, 10, v21
    v_lshrrev_b32 v46, 3, v1
    v_lshlrev_b32 v45, 4, v45
    v_lshl_add_u32 v36, v46, 8, v45
    v_lshlrev_b32 v37, 4, v46
    s_mul_i32 s96, s95, 320
    s_add_u32 s96, s96, s77
    v_lshl_add_u32 v38, v3, 2, v45
    v_add_u32 v38, s96, v38
    s_and_b32 s96, s3, 3
    s_lshl_b32 s96, s96, 9
    s_add_u32 s96, s96, 30208
    v_lshrrev_b32 v46, 5, v1
    v_lshl_add_u32 v19, v46, 11, v22
    v_add_u32 v19, s96, v19
    v_and_b32 v45, 3, v1
    v_lshrrev_b32 v46, 2, v1
    v_lshlrev_b32 v40, 4, v45
    v_lshl_add_u32 v40, v46, 12, v40
    s_bfe_u32 s96, s2, 0x20004
    s_lshr_b32 s89, s2, 6
    s_lshl2_add_u32 s96, s96, s89
    s_and_b32 s89, s2, 15
    s_lshl4_add_u32 s96, s96, s89
    s_lshl_b32 s89, s96, 12
    s_add_u32 s89, s89, 5242880
Lb1_3:
    s_waitcnt lgkmcnt(0)
    s_barrier
    ds_read_b128 v[204:207], v15 offset:13568
    ds_read_b128 v[148:151], v16 offset:13568
    ds_read_b128 v[152:155], v16 offset:13584
    s_waitcnt lgkmcnt(2)
    v_and_b32 v212, v204, v4
    v_and_b32 v213, v204, v5
    v_and_b32 v214, v205, v4
    v_and_b32 v215, v205, v5
    v_and_b32 v216, v206, v4
    v_and_b32 v217, v206, v5
    v_and_b32 v218, v207, v4
    v_and_b32 v219, v207, v5
    s_waitcnt vmcnt(5)
    buffer_load_dwordx4 v12, s[32:35], s73 offen offset:1024 nt lds
    v_mfma_f32_16x16x16_bf16 v[180:183], v[212:213], v[52:53], 0
    v_mfma_f32_16x16x16_bf16 v[184:187], v[212:213], v[54:55], 0
    s_waitcnt vmcnt(5)
    buffer_load_dwordx4 v13, s[32:35], s73 offen offset:2048 nt lds
    v_mfma_f32_16x16x16_bf16 v[180:183], v[214:215], v[56:57], v[180:183]
    v_mfma_f32_16x16x16_bf16 v[184:187], v[214:215], v[58:59], v[184:187]
    s_waitcnt vmcnt(5)
    buffer_load_dwordx4 v14, s[32:35], s73 offen offset:3072 nt lds
    v_mfma_f32_16x16x16_bf16 v[180:183], v[216:217], v[60:61], v[180:183]
    v_mfma_f32_16x16x16_bf16 v[184:187], v[216:217], v[62:63], v[184:187]
    s_waitcnt vmcnt(5)
    buffer_load_dwordx4 v[68:71], v10, s[36:39], s73 offen nt
    v_mfma_f32_16x16x16_bf16 v[180:183], v[218:219], v[64:65], v[180:183]
    v_mfma_f32_16x16x16_bf16 v[184:187], v[218:219], v[66:67], v[184:187]
    s_waitcnt lgkmcnt(0)
    v_and_b32 v52, v148, v4
    v_and_b32 v53, v148, v5
    v_and_b32 v54, v149, v4
    v_and_b32 v55, v149, v5
    v_and_b32 v56, v150, v4
    v_and_b32 v57, v150, v5
    v_and_b32 v58, v151, v4
    v_and_b32 v59, v151, v5
    v_and_b32 v60, v152, v4
    v_and_b32 v61, v152, v5
    v_and_b32 v62, v153, v4
    v_and_b32 v63, v153, v5
    v_and_b32 v64, v154, v4
    v_and_b32 v65, v154, v5
    v_and_b32 v66, v155, v4
    v_and_b32 v67, v155, v5
    s_add_u32 s65, s64, 17
    s_and_b32 s65, s65, 0xff
    s_add_u32 s66, s64, 74
    s_and_b32 s66, s66, 0xff
    s_add_u32 s67, s64, 199
    s_and_b32 s67, s67, 0xff
    s_add_u32 s68, s64, 142
    s_and_b32 s68, s68, 0xff
    ds_write_b128 v17, v[180:183]
    ds_write_b128 v17, v[184:187] offset:16
    s_waitcnt lgkmcnt(0)
    s_barrier
    ds_read_b128 v[148:151], v18
    ds_read_b128 v[152:155], v18 offset:2048
    ds_read_b128 v[156:159], v18 offset:4096
    ds_read_b128 v[160:163], v18 offset:6144
    ds_read_b128 v[164:167], v18 offset:8192
    ds_read_b128 v[168:171], v18 offset:10240
    ds_read_b128 v[172:175], v18 offset:12288
    ds_read_b128 v[176:179], v18 offset:14336
    s_waitcnt lgkmcnt(6)
    v_pk_add_f32 v[148:149], v[148:149], v[152:153]
    v_pk_add_f32 v[150:151], v[150:151], v[154:155]
    s_waitcnt lgkmcnt(4)
    v_pk_add_f32 v[156:157], v[156:157], v[160:161]
    v_pk_add_f32 v[158:159], v[158:159], v[162:163]
    s_waitcnt lgkmcnt(2)
    v_pk_add_f32 v[164:165], v[164:165], v[168:169]
    v_pk_add_f32 v[166:167], v[166:167], v[170:171]
    s_waitcnt lgkmcnt(0)
    v_pk_add_f32 v[172:173], v[172:173], v[176:177]
    v_pk_add_f32 v[174:175], v[174:175], v[178:179]
    v_pk_add_f32 v[148:149], v[148:149], v[156:157]
    v_pk_add_f32 v[150:151], v[150:151], v[158:159]
    v_pk_add_f32 v[164:165], v[164:165], v[172:173]
    v_pk_add_f32 v[166:167], v[166:167], v[174:175]
    v_pk_add_f32 v[228:229], v[148:149], v[164:165]
    v_pk_add_f32 v[230:231], v[150:151], v[166:167]
    v_add_u32 v228, 0x80, v228
    v_add_u32 v229, 0x80, v229
    v_add_u32 v230, 0x80, v230
    v_add_u32 v231, 0x80, v231
    v_bfi_b32 v228, v6, s65, v228
    v_bfi_b32 v229, v6, s66, v229
    v_bfi_b32 v230, v6, s67, v230
    v_bfi_b32 v231, v6, s68, v231
    s_mov_b64 exec, 0xffff
    buffer_store_dwordx4 v[228:231], v21, s[60:63], s80 offen sc1
    s_mov_b64 exec, -1
    s_lshl_b32 s96, s66, 8
    s_or_b32 s69, s65, s96
    s_lshl_b32 s96, s67, 16
    s_or_b32 s69, s69, s96
    s_lshl_b32 s96, s68, 24
    s_or_b32 s69, s69, s96
    s_cmp_ge_u32 s3, 4
    s_cbranch_scc1 Lskipdef_4
    s_mov_b32 s70, 0x0c0c0400
    s_mov_b32 s71, 0x04000c0c
    s_lshl3_add_u32 s78, s76, s3
    s_lshl_b32 s81, s78, 12
    s_add_u32 s81, s81, 1048576
    s_and_b32 s78, s76, 3
    s_lshl3_add_u32 s78, s78, s3
    s_lshr_b32 s79, s76, 2
    s_lshl3_add_u32 s96, s78, s79
    s_lshl4_add_u32 s96, s96, s77
    s_lshl_b32 s82, s96, 8
    s_add_u32 s82, s82, 2097152
    s_lshl2_add_u32 s96, s78, s79
    s_lshl4_add_u32 s96, s96, s77
    s_lshl_b32 s83, s96, 4
    s_add_u32 s83, s83, 3145728
    s_and_b32 s78, s2, 7
    s_lshr_b32 s79, s2, 5
    s_lshl3_add_u32 s78, s79, s78
    s_bfe_u32 s79, s2, 0x20003
    s_bfe_u32 s96, s2, 0x10004
    s_xor_b32 s96, s96, 1
    s_and_b32 s79, s79, 1
    s_lshl1_add_u32 s79, s79, s96
    s_lshl2_add_u32 s76, s78, s95
    s_lshl_b32 s75, s76, 15
    s_lshl1_add_u32 s96, s79, s97
    s_lshl_b32 s96, s96, 8
    s_add_u32 s75, s75, s96
    s_lshl_b32 s77, s97, 7
    s_lshl_b32 s85, s76, 12
    s_add_u32 s85, s85, s77
    s_add_u32 s85, s85, 2097152
    s_lshl_b32 s87, s76, 11
    s_add_u32 s87, s87, s77
    s_add_u32 s87, s87, 4194304
    s_mov_b32 s52, s20
    s_mov_b32 s53, s21
    s_mov_b32 s54, 7340032
    s_mov_b32 s55, 0x00020000
    s_lshr_b32 s96, s78, 1
    s_lshl2_add_u32 s96, s96, s95
    s_lshl_b32 s86, s96, 8
    s_add_u32 s86, s86, 3145728
    s_and_b32 s96, s3, 3
    s_lshl2_add_u32 s96, s79, s96
    s_lshl_b32 s88, s96, 16
    s_lshl_b32 s96, s78, 6
    s_add_u32 s88, s88, s96
    s_add_u32 s88, s88, 5242880
    s_mov_b32 s44, s12
    s_mov_b32 s45, s13
    s_mov_b32 s46, 8388608
    s_mov_b32 s47, 0x00020000
    s_mov_b32 s56, s22
    s_mov_b32 s57, s23
    s_mov_b32 s58, 8192
    s_mov_b32 s59, 0x00020000
    v_lshl_add_u32 v9, v3, 13, v21
    v_and_b32 v22, 31, v1
    v_lshlrev_b32 v22, 4, v22
    v_xor_b32 v24, 64, v23
    v_xor_b32 v25, 0x80, v23
    v_xor_b32 v26, 0xc0, v23
    v_and_b32 v45, 7, v1
    v_mul_u32_u24 v27, 272, v45
    v_lshl_add_u32 v27, v3, 4, v27
    s_mul_i32 s96, s3, 272
    v_lshrrev_b32 v28, 1, v22
    v_lshrrev_b32 v46, 5, v1
    v_lshl_add_u32 v28, v46, 2, v28
    v_add_u32 v28, s96, v28
    s_lshl_b32 s96, s3, 10
    v_lshlrev_b32 v46, 4, v3
    v_lshl_add_u32 v29, v2, 6, v46
    v_add_u32 v29, s96, v29
    v_lshrrev_b32 v47, 2, v2
    v_lshl_add_u32 v30, v47, 6, v46
    v_add_u32 v30, s96, v30
    v_mul_u32_u24 v39, 320, v47
    v_add_u32 v39, v39, v46
    s_lshl_b32 s96, s95, 6
    v_add_u32 v39, s96, v39
    s_lshl_b32 s96, s3, 3
    v_lshlrev_b32 v31, 6, v2
    v_add_u32 v31, s96, v31
    s_lshl_b32 s96, s3, 6
    v_lshlrev_b32 v33, 3, v45
    v_add_u32 v33, s96, v33
    s_lshl_b32 s96, s3, 9
    s_add_u32 s96, s96, 46592
    v_add_u32 v34, s96, v22
    v_and_b32 v35, 16, v1
    v_lshl_add_u32 v35, v35, 10, v21
    v_lshrrev_b32 v46, 3, v1
    v_lshlrev_b32 v45, 4, v45
    v_lshl_add_u32 v36, v46, 8, v45
    v_lshlrev_b32 v37, 4, v46
    s_mul_i32 s96, s95, 320
    s_add_u32 s96, s96, s77
    v_lshl_add_u32 v38, v3, 2, v45
    v_add_u32 v38, s96, v38
    s_and_b32 s96, s3, 3
    s_lshl_b32 s96, s96, 9
    s_add_u32 s96, s96, 30208
    v_lshrrev_b32 v46, 5, v1
    v_lshl_add_u32 v19, v46, 11, v22
    v_add_u32 v19, s96, v19
    v_and_b32 v45, 3, v1
    v_lshrrev_b32 v46, 2, v1
    v_lshlrev_b32 v40, 4, v45
    v_lshl_add_u32 v40, v46, 12, v40
    s_bfe_u32 s96, s2, 0x20004
    s_lshr_b32 s89, s2, 6
    s_lshl2_add_u32 s96, s96, s89
    s_and_b32 s89, s2, 15
    s_lshl4_add_u32 s96, s96, s89
    s_lshl_b32 s89, s96, 12
    s_add_u32 s89, s89, 5242880
Lskipdef_4:
    s_waitcnt vmcnt(5)
    buffer_load_dwordx4 v[72:75], v10, s[36:39], s73 offen offset:256 nt
    s_waitcnt vmcnt(5)
    buffer_load_dwordx4 v[76:79], v10, s[36:39], s73 offen offset:512 nt
    s_waitcnt vmcnt(5)
    buffer_load_dwordx4 v[80:83], v10, s[36:39], s73 offen offset:768 nt
    s_waitcnt vmcnt(5)
    buffer_load_dwordx4 v[84:87], v8, s[48:51], s74 offen nt
    s_waitcnt vmcnt(5)
    s_add_u32 s96, s74, 7168
    buffer_load_dwordx4 v[88:91], v8, s[48:51], s96 offen nt
    s_waitcnt vmcnt(4)
    s_barrier
    buffer_load_dwordx4 v[148:151], v20, s[60:63], s81 offen
    buffer_load_dwordx4 v[152:155], v20, s[60:63], s81 offen offset:1024
    buffer_load_dwordx4 v[156:159], v20, s[60:63], s81 offen offset:2048
    buffer_load_dwordx4 v[160:163], v20, s[60:63], s81 offen offset:3072
    s_barrier
    s_add_u32 s96, s74, 14336
    buffer_load_dwordx4 v[92:95], v8, s[48:51], s96 offen nt
    s_add_u32 s96, s74, 21504
    buffer_load_dwordx4 v[96:99], v8, s[48:51], s96 offen nt
    s_waitcnt vmcnt(5)
    v_perm_b32 v45, v149, v148, s70
    v_perm_b32 v46, v151, v150, s71
    v_or_b32 v45, v45, v46
    v_cmp_ne_u32 s[12:13], s69, v45
    s_waitcnt vmcnt(4)
    v_perm_b32 v45, v153, v152, s70
    v_perm_b32 v46, v155, v154, s71
    v_or_b32 v45, v45, v46
    v_cmp_ne_u32 s[14:15], s69, v45
    s_waitcnt vmcnt(3)
    v_perm_b32 v45, v157, v156, s70
    v_perm_b32 v46, v159, v158, s71
    v_or_b32 v45, v45, v46
    v_cmp_ne_u32 s[16:17], s69, v45
    s_waitcnt vmcnt(2)
    v_perm_b32 v45, v161, v160, s70
    v_perm_b32 v46, v163, v162, s71
    v_or_b32 v45, v45, v46
    v_cmp_ne_u32 s[18:19], s69, v45
    s_mov_b32 s94, 0
    s_or_b64 s[92:93], s[12:13], s[14:15]
    s_or_b64 s[92:93], s[92:93], s[16:17]
    s_or_b64 s[92:93], s[92:93], s[18:19]
    s_nop 0
    s_cbranch_scc0 Lok_5
Lre_6:
    s_add_u32 s94, s94, 1
    s_cmp_ge_u32 s94, 100000
    s_cbranch_scc1 Lok_5
    s_mov_b64 exec, s[12:13]
    s_cbranch_execz Lsk_7
    buffer_load_dwordx4 v[148:151], v20, s[60:63], s81 offen sc1
Lsk_7:
    s_mov_b64 exec, s[14:15]
    s_cbranch_execz Lsk_8
    buffer_load_dwordx4 v[152:155], v20, s[60:63], s81 offen offset:1024 sc1
Lsk_8:
    s_mov_b64 exec, s[16:17]
    s_cbranch_execz Lsk_9
    buffer_load_dwordx4 v[156:159], v20, s[60:63], s81 offen offset:2048 sc1
Lsk_9:
    s_mov_b64 exec, s[18:19]
    s_cbranch_execz Lsk_10
    buffer_load_dwordx4 v[160:163], v20, s[60:63], s81 offen offset:3072 sc1
Lsk_10:
    s_waitcnt vmcnt(0)
    s_mov_b64 exec, s[12:13]
    v_perm_b32 v45, v149, v148, s70
    v_perm_b32 v46, v151, v150, s71
    v_or_b32 v45, v45, v46
    v_cmp_ne_u32 s[12:13], s69, v45
    s_mov_b64 exec, s[14:15]
    v_perm_b32 v45, v153, v152, s70
    v_perm_b32 v46, v155, v154, s71
    v_or_b32 v45, v45, v46
    v_cmp_ne_u32 s[14:15], s69, v45
    s_mov_b64 exec, s[16:17]
    v_perm_b32 v45, v157, v156, s70
    v_perm_b32 v46, v159, v158, s71
    v_or_b32 v45, v45, v46
    v_cmp_ne_u32 s[16:17], s69, v45
    s_mov_b64 exec, s[18:19]
    v_perm_b32 v45, v161, v160, s70
    v_perm_b32 v46, v163, v162, s71
    v_or_b32 v45, v45, v46
    v_cmp_ne_u32 s[18:19], s69, v45
    s_mov_b64 exec, -1
    s_or_b64 s[92:93], s[12:13], s[14:15]
    s_or_b64 s[92:93], s[92:93], s[16:17]
    s_or_b64 s[92:93], s[92:93], s[18:19]
    s_nop 0
    s_cbranch_scc1 Lre_6
Lok_5:
    s_mov_b64 exec, -1
    v_and_b32 v148, 0xffffff00, v148
    v_and_b32 v149, 0xffffff00, v149
    v_and_b32 v150, 0xffffff00, v150
    v_and_b32 v151, 0xffffff00, v151
    v_and_b32 v152, 0xffffff00, v152
    v_and_b32 v153, 0xffffff00, v153
    v_and_b32 v154, 0xffffff00, v154
    v_and_b32 v155, 0xffffff00, v155
    v_and_b32 v156, 0xffffff00, v156
    v_and_b32 v157, 0xffffff00, v157
    v_and_b32 v158, 0xffffff00, v158
    v_and_b32 v159, 0xffffff00, v159
    v_and_b32 v160, 0xffffff00, v160
    v_and_b32 v161, 0xffffff00, v161
    v_and_b32 v162, 0xffffff00, v162
    v_and_b32 v163, 0xffffff00, v163
    v_pk_add_f32 v[148:149], v[148:149], v[152:153]
    v_pk_add_f32 v[156:157], v[156:157], v[160:161]
    v_pk_add_f32 v[150:151], v[150:151], v[154:155]
    v_pk_add_f32 v[158:159], v[158:159], v[162:163]
    v_pk_add_f32 v[148:149], v[148:149], v[156:157]
    v_pk_add_f32 v[150:151], v[150:151], v[158:159]
    s_nop 1
    v_permlane32_swap_b32 v148, v150
    v_add_f32 v148, v148, v150
    v_permlane32_swap_b32 v149, v151
    v_add_f32 v149, v149, v151
    v_cvt_pk_bf16_f32 v152, v148, v149
    ds_write_b32 v28, v152
    s_add_u32 s96, s74, 28672
    buffer_load_dwordx4 v[100:103], v8, s[48:51], s96 offen nt
    s_waitcnt lgkmcnt(0)
    s_barrier
    ds_read_b128 v[164:167], v23
    ds_read_b128 v[212:215], v27
    ds_read_b128 v[168:171], v24
    ds_read_b128 v[216:219], v27 offset:64
    ds_read_b128 v[172:175], v25
    ds_read_b128 v[220:223], v27 offset:128
    ds_read_b128 v[176:179], v26
    ds_read_b128 v[224:227], v27 offset:192
    s_waitcnt lgkmcnt(6)
    v_mfma_f32_16x16x32_bf16 v[228:231], v[164:167], v[212:215], 0
    s_waitcnt lgkmcnt(4)
    v_mfma_f32_16x16x32_bf16 v[228:231], v[168:171], v[216:219], v[228:231]
    s_waitcnt lgkmcnt(2)
    v_mfma_f32_16x16x32_bf16 v[228:231], v[172:175], v[220:223], v[228:231]
    s_waitcnt lgkmcnt(0)
    v_mfma_f32_16x16x32_bf16 v[228:231], v[176:179], v[224:227], v[228:231]
    s_add_u32 s96, s74, 35840
    buffer_load_dwordx4 v[104:107], v8, s[48:51], s96 offen nt
    s_nop 5
    v_cvt_pk_bf16_f32 v236, v228, v229
    v_cvt_pk_bf16_f32 v237, v230, v231
    v_lshlrev_b32 v232, 16, v236
    v_and_b32 v233, 0xffff0000, v236
    v_lshlrev_b32 v234, 16, v237
    v_and_b32 v235, 0xffff0000, v237
    v_mul_f32 v232, 0x3db504f3, v232
    v_mul_f32 v233, 0x3db504f3, v233
    v_mul_f32 v234, 0x3db504f3, v234
    v_mul_f32 v235, 0x3db504f3, v235
    v_cvt_pk_bf16_f32 v236, v232, v233
    v_cvt_pk_bf16_f32 v237, v234, v235
    v_lshlrev_b32 v232, 16, v236
    v_and_b32 v233, 0xffff0000, v236
    v_lshlrev_b32 v234, 16, v237
    v_and_b32 v235, 0xffff0000, v237
    v_max3_f32 v238, v232, v233, v234
    v_max_f32 v238, v238, v235
    v_mov_b32 v240, v238
    s_nop 1
    v_permlane16_swap_b32 v238, v240
    v_max_f32 v238, v238, v240
    v_mov_b32 v240, v238
    s_nop 1
    v_permlane32_swap_b32 v238, v240
    v_max_f32 v238, v238, v240
    v_sub_f32 v232, v232, v238
    v_sub_f32 v233, v233, v238
    v_sub_f32 v234, v234, v238
    v_sub_f32 v235, v235, v238
    v_mul_f32 v232, 0x3fb8aa3b, v232
    v_mul_f32 v233, 0x3fb8aa3b, v233
    v_mul_f32 v234, 0x3fb8aa3b, v234
    v_mul_f32 v235, 0x3fb8aa3b, v235
    v_exp_f32 v232, v232
    v_exp_f32 v233, v233
    v_exp_f32 v234, v234
    v_exp_f32 v235, v235
    v_cvt_pk_bf16_f32 v228, v232, v232
    v_cvt_pk_bf16_f32 v229, v233, v233
    v_cvt_pk_bf16_f32 v230, v234, v234
    v_cvt_pk_bf16_f32 v231, v235, v235
    ds_write_b128 v29, v[228:231] offset:5376
    ds_read_b128 v[204:207], v30 offset:5376
    ds_read_b128 v[208:211], v30 offset:5632
    v_add_f32 v239, v232, v233
    v_add_f32 v240, v234, v235
    v_add_f32 v239, v239, v240
    v_mov_b32 v240, v239
    s_nop 1
    v_permlane16_swap_b32 v239, v240
    v_add_f32 v239, v239, v240
    v_mov_b32 v240, v239
    s_nop 1
    v_permlane32_swap_b32 v239, v240
    v_add_f32 v239, v239, v240
    s_mov_b64 exec, 0xff
    ds_write_b64 v31, v[238:239] offset:2176
    s_mov_b64 exec, -1
    s_waitcnt lgkmcnt(1)
    v_and_b32 v212, v204, v4
    v_and_b32 v213, v204, v5
    v_and_b32 v214, v205, v4
    v_and_b32 v215, v205, v5
    v_and_b32 v216, v206, v4
    v_and_b32 v217, v206, v5
    v_and_b32 v218, v207, v4
    v_and_b32 v219, v207, v5
    v_and_b32 v220, v208, v4
    v_and_b32 v221, v208, v5
    v_and_b32 v222, v209, v4
    v_and_b32 v223, v209, v5
    v_and_b32 v224, v210, v4
    v_and_b32 v225, v210, v5
    v_and_b32 v226, v211, v4
    v_and_b32 v227, v211, v5
    v_mfma_f32_16x16x16_bf16 v[180:183], v[212:213], v[68:69], 0
    v_mfma_f32_16x16x16_bf16 v[184:187], v[212:213], v[70:71], 0
    v_mfma_f32_16x16x16_bf16 v[188:191], v[220:221], v[68:69], 0
    v_mfma_f32_16x16x16_bf16 v[192:195], v[220:221], v[70:71], 0
    v_mfma_f32_16x16x16_bf16 v[180:183], v[214:215], v[72:73], v[180:183]
    v_mfma_f32_16x16x16_bf16 v[184:187], v[214:215], v[74:75], v[184:187]
    v_mfma_f32_16x16x16_bf16 v[188:191], v[222:223], v[72:73], v[188:191]
    v_mfma_f32_16x16x16_bf16 v[192:195], v[222:223], v[74:75], v[192:195]
    s_waitcnt vmcnt(11)
    s_add_u32 s96, s74, 43008
    buffer_load_dwordx4 v[108:111], v8, s[48:51], s96 offen nt
    v_mfma_f32_16x16x16_bf16 v[180:183], v[216:217], v[76:77], v[180:183]
    v_mfma_f32_16x16x16_bf16 v[184:187], v[216:217], v[78:79], v[184:187]
    v_mfma_f32_16x16x16_bf16 v[188:191], v[224:225], v[76:77], v[188:191]
    v_mfma_f32_16x16x16_bf16 v[192:195], v[224:225], v[78:79], v[192:195]
    s_waitcnt vmcnt(11)
    s_add_u32 s96, s74, 50176
    buffer_load_dwordx4 v[112:115], v8, s[48:51], s96 offen nt
    v_mfma_f32_16x16x16_bf16 v[180:183], v[218:219], v[80:81], v[180:183]
    v_mfma_f32_16x16x16_bf16 v[184:187], v[218:219], v[82:83], v[184:187]
    v_mfma_f32_16x16x16_bf16 v[188:191], v[226:227], v[80:81], v[188:191]
    v_mfma_f32_16x16x16_bf16 v[192:195], v[226:227], v[82:83], v[192:195]
    buffer_load_dwordx4 v[116:119], v9, s[44:47], s75 offen nt
    s_nop 3
    ds_write_b128 v32, v[180:183]
    ds_write_b128 v32, v[184:187] offset:16
    ds_write_b128 v32, v[188:191] offset:2048
    ds_write_b128 v32, v[192:195] offset:2064
    s_waitcnt lgkmcnt(0)
    s_barrier
    ds_read_b64 v[236:237], v33 offset:2176
    ds_read_b128 v[148:151], v34
    ds_read_b128 v[152:155], v34 offset:4096
    ds_read_b128 v[156:159], v34 offset:8192
    ds_read_b128 v[160:163], v34 offset:12288
    ds_read_b128 v[164:167], v34 offset:16384
    ds_read_b128 v[168:171], v34 offset:20480
    ds_read_b128 v[172:175], v34 offset:24576
    ds_read_b128 v[176:179], v34 offset:28672
    s_waitcnt lgkmcnt(8)
    v_mov_b32 v232, v236
    s_nop 1
    v_max_f32_dpp v232, v232, v232 quad_perm:[1,0,3,2] row_mask:0xf bank_mask:0xf
    s_nop 1
    v_max_f32_dpp v232, v232, v232 quad_perm:[2,3,0,1] row_mask:0xf bank_mask:0xf
    s_nop 1
    v_max_f32_dpp v232, v232, v232 row_half_mirror row_mask:0xf bank_mask:0xf
    v_sub_f32 v236, v236, v232
    v_mul_f32 v236, 0x3fb8aa3b, v236
    v_exp_f32 v236, v236
    s_nop 0
    v_mul_f32 v233, v236, v237
    v_readlane_b32 s4, v236, 0
    v_readlane_b32 s5, v236, 1
    v_readlane_b32 s6, v236, 2
    v_readlane_b32 s7, v236, 3
    v_readlane_b32 s8, v236, 4
    v_readlane_b32 s9, v236, 5
    v_readlane_b32 s10, v236, 6
    v_readlane_b32 s11, v236, 7
    v_add_f32_dpp v233, v233, v233 quad_perm:[1,0,3,2] row_mask:0xf bank_mask:0xf
    s_nop 1
    v_add_f32_dpp v233, v233, v233 quad_perm:[2,3,0,1] row_mask:0xf bank_mask:0xf
    s_nop 1
    v_add_f32_dpp v233, v233, v233 row_half_mirror row_mask:0xf bank_mask:0xf
    v_mov_b32 v234, 0
    v_mov_b32 v235, 0
    s_waitcnt lgkmcnt(7)
    v_pk_mul_f32 v[228:229], v[148:149], s[4:5] op_sel_hi:[1,0]
    v_pk_mul_f32 v[230:231], v[150:151], s[4:5] op_sel_hi:[1,0]
    s_waitcnt lgkmcnt(6)
    v_pk_fma_f32 v[228:229], v[152:153], s[4:5], v[228:229] op_sel:[0,1,0] op_sel_hi:[1,1,1]
    v_pk_fma_f32 v[230:231], v[154:155], s[4:5], v[230:231] op_sel:[0,1,0] op_sel_hi:[1,1,1]
    s_waitcnt lgkmcnt(5)
    v_pk_fma_f32 v[228:229], v[156:157], s[6:7], v[228:229] op_sel_hi:[1,0,1]
    v_pk_fma_f32 v[230:231], v[158:159], s[6:7], v[230:231] op_sel_hi:[1,0,1]
    s_waitcnt lgkmcnt(4)
    v_pk_fma_f32 v[228:229], v[160:161], s[6:7], v[228:229] op_sel:[0,1,0] op_sel_hi:[1,1,1]
    v_pk_fma_f32 v[230:231], v[162:163], s[6:7], v[230:231] op_sel:[0,1,0] op_sel_hi:[1,1,1]
    s_waitcnt lgkmcnt(3)
    v_pk_fma_f32 v[228:229], v[164:165], s[8:9], v[228:229] op_sel_hi:[1,0,1]
    v_pk_fma_f32 v[230:231], v[166:167], s[8:9], v[230:231] op_sel_hi:[1,0,1]
    s_waitcnt lgkmcnt(2)
    v_pk_fma_f32 v[228:229], v[168:169], s[8:9], v[228:229] op_sel:[0,1,0] op_sel_hi:[1,1,1]
    v_pk_fma_f32 v[230:231], v[170:171], s[8:9], v[230:231] op_sel:[0,1,0] op_sel_hi:[1,1,1]
    s_waitcnt lgkmcnt(1)
    v_pk_fma_f32 v[228:229], v[172:173], s[10:11], v[228:229] op_sel_hi:[1,0,1]
    v_pk_fma_f32 v[230:231], v[174:175], s[10:11], v[230:231] op_sel_hi:[1,0,1]
    s_waitcnt lgkmcnt(0)
    v_pk_fma_f32 v[228:229], v[176:177], s[10:11], v[228:229] op_sel:[0,1,0] op_sel_hi:[1,1,1]
    v_pk_fma_f32 v[230:231], v[178:179], s[10:11], v[230:231] op_sel:[0,1,0] op_sel_hi:[1,1,1]
    v_add_u32 v232, 0x80, v232
    v_add_u32 v233, 0x80, v233
    v_add_u32 v234, 0x80, v234
    v_add_u32 v235, 0x80, v235
    v_bfi_b32 v232, v6, s65, v232
    v_bfi_b32 v233, v6, s66, v233
    v_bfi_b32 v234, v6, s67, v234
    v_bfi_b32 v235, v6, s68, v235
    v_add_u32 v228, 0x80, v228
    v_add_u32 v229, 0x80, v229
    v_add_u32 v230, 0x80, v230
    v_add_u32 v231, 0x80, v231
    v_bfi_b32 v228, v6, s65, v228
    v_bfi_b32 v229, v6, s66, v229
    v_bfi_b32 v230, v6, s67, v230
    v_bfi_b32 v231, v6, s68, v231
    s_mov_b32 exec_hi, 0
    buffer_store_dwordx4 v[228:231], v35, s[60:63], s82 offen sc1
    s_mov_b64 exec, 1
    buffer_store_dwordx4 v[232:235], off, s[60:63], s83 sc1
    s_mov_b64 exec, -1
    buffer_load_dwordx4 v[120:123], v9, s[44:47], s75 offen offset:2048 nt
    s_waitcnt vmcnt(15)
    v_mfma_f32_16x16x16_bf16 v[196:199], v[52:53], v[84:85], 0
    v_mfma_f32_16x16x16_bf16 v[200:203], v[52:53], v[86:87], 0
    s_waitcnt vmcnt(14)
    v_mfma_f32_16x16x16_bf16 v[196:199], v[54:55], v[88:89], v[196:199]
    v_mfma_f32_16x16x16_bf16 v[200:203], v[54:55], v[90:91], v[200:203]
    s_waitcnt vmcnt(9)
    v_mfma_f32_16x16x16_bf16 v[196:199], v[56:57], v[92:93], v[196:199]
    v_mfma_f32_16x16x16_bf16 v[200:203], v[56:57], v[94:95], v[200:203]
    s_waitcnt vmcnt(8)
    v_mfma_f32_16x16x16_bf16 v[196:199], v[58:59], v[96:97], v[196:199]
    v_mfma_f32_16x16x16_bf16 v[200:203], v[58:59], v[98:99], v[200:203]
    s_waitcnt vmcnt(7)
    v_mfma_f32_16x16x16_bf16 v[196:199], v[60:61], v[100:101], v[196:199]
    v_mfma_f32_16x16x16_bf16 v[200:203], v[60:61], v[102:103], v[200:203]
    s_waitcnt vmcnt(6)
    v_mfma_f32_16x16x16_bf16 v[196:199], v[62:63], v[104:105], v[196:199]
    v_mfma_f32_16x16x16_bf16 v[200:203], v[62:63], v[106:107], v[200:203]
    s_waitcnt vmcnt(5)
    v_mfma_f32_16x16x16_bf16 v[196:199], v[64:65], v[108:109], v[196:199]
    v_mfma_f32_16x16x16_bf16 v[200:203], v[64:65], v[110:111], v[200:203]
    s_waitcnt vmcnt(4)
    v_mfma_f32_16x16x16_bf16 v[196:199], v[66:67], v[112:113], v[196:199]
    v_mfma_f32_16x16x16_bf16 v[200:203], v[66:67], v[114:115], v[200:203]
    s_nop 6
    ds_write_b128 v17, v[196:199]
    ds_write_b128 v17, v[200:203] offset:16
    s_waitcnt lgkmcnt(0)
    s_barrier
    ds_read_b128 v[148:151], v18
    ds_read_b128 v[152:155], v18 offset:2048
    ds_read_b128 v[156:159], v18 offset:4096
    ds_read_b128 v[160:163], v18 offset:6144
    ds_read_b128 v[164:167], v18 offset:8192
    ds_read_b128 v[168:171], v18 offset:10240
    ds_read_b128 v[172:175], v18 offset:12288
    ds_read_b128 v[176:179], v18 offset:14336
    s_waitcnt lgkmcnt(6)
    v_pk_add_f32 v[148:149], v[148:149], v[152:153]
    v_pk_add_f32 v[150:151], v[150:151], v[154:155]
    s_waitcnt lgkmcnt(4)
    v_pk_add_f32 v[156:157], v[156:157], v[160:161]
    v_pk_add_f32 v[158:159], v[158:159], v[162:163]
    s_waitcnt lgkmcnt(2)
    v_pk_add_f32 v[164:165], v[164:165], v[168:169]
    v_pk_add_f32 v[166:167], v[166:167], v[170:171]
    s_waitcnt lgkmcnt(0)
    v_pk_add_f32 v[172:173], v[172:173], v[176:177]
    v_pk_add_f32 v[174:175], v[174:175], v[178:179]
    v_pk_add_f32 v[148:149], v[148:149], v[156:157]
    v_pk_add_f32 v[150:151], v[150:151], v[158:159]
    v_pk_add_f32 v[164:165], v[164:165], v[172:173]
    v_pk_add_f32 v[166:167], v[166:167], v[174:175]
    v_pk_add_f32 v[228:229], v[148:149], v[164:165]
    v_pk_add_f32 v[230:231], v[150:151], v[166:167]
    v_add_u32 v228, 0x80, v228
    v_add_u32 v229, 0x80, v229
    v_add_u32 v230, 0x80, v230
    v_add_u32 v231, 0x80, v231
    v_bfi_b32 v228, v6, s65, v228
    v_bfi_b32 v229, v6, s66, v229
    v_bfi_b32 v230, v6, s67, v230
    v_bfi_b32 v231, v6, s68, v231
    s_mov_b64 exec, 0xffff
    buffer_store_dwordx4 v[228:231], v21, s[60:63], s84 offen sc1
    s_mov_b64 exec, -1
    s_add_u32 s96, s75, 4096
    buffer_load_dwordx4 v[124:127], v9, s[44:47], s96 offen nt
    s_add_u32 s96, s75, 6144
    buffer_load_dwordx4 v[128:131], v9, s[44:47], s96 offen nt
    buffer_load_dwordx4 v[132:135], v9, s[52:55], s75 offen nt
    s_waitcnt vmcnt(7)
    buffer_load_dwordx4 v[136:139], v9, s[52:55], s75 offen offset:2048 nt
    s_waitcnt vmcnt(5)
    s_add_u32 s96, s75, 4096
    buffer_load_dwordx4 v[140:143], v9, s[52:55], s96 offen nt
    s_waitcnt vmcnt(4)
    s_barrier
    buffer_load_dwordx4 v[156:159], v37, s[60:63], s86 offen
    buffer_load_dwordx4 v[160:163], v37, s[60:63], s86 offen offset:128
    buffer_load_dwordx4 v[148:151], v36, s[60:63], s85 offen
    buffer_load_dwordx4 v[152:155], v36, s[60:63], s85 offen offset:2048
    buffer_load_dwordx4 v[164:167], v36, s[60:63], s87 offen
    s_barrier
    s_add_u32 s96, s75, 6144
    buffer_load_dwordx4 v[144:147], v9, s[52:55], s96 offen nt
    s_waitcnt vmcnt(5)
    v_perm_b32 v45, v157, v156, s70
    v_perm_b32 v46, v159, v158, s71
    v_or_b32 v45, v45, v46
    v_cmp_ne_u32 s[12:13], s69, v45
    s_waitcnt vmcnt(4)
    v_perm_b32 v45, v161, v160, s70
    v_perm_b32 v46, v163, v162, s71
    v_or_b32 v45, v45, v46
    v_cmp_ne_u32 s[14:15], s69, v45
    s_waitcnt vmcnt(3)
    v_perm_b32 v45, v149, v148, s70
    v_perm_b32 v46, v151, v150, s71
    v_or_b32 v45, v45, v46
    v_cmp_ne_u32 s[16:17], s69, v45
    s_waitcnt vmcnt(2)
    v_perm_b32 v45, v153, v152, s70
    v_perm_b32 v46, v155, v154, s71
    v_or_b32 v45, v45, v46
    v_cmp_ne_u32 s[18:19], s69, v45
    s_waitcnt vmcnt(1)
    v_perm_b32 v45, v165, v164, s70
    v_perm_b32 v46, v167, v166, s71
    v_or_b32 v45, v45, v46
    v_cmp_ne_u32 s[20:21], s69, v45
    s_mov_b32 s94, 0
    s_or_b64 s[92:93], s[12:13], s[14:15]
    s_or_b64 s[92:93], s[92:93], s[16:17]
    s_or_b64 s[92:93], s[92:93], s[18:19]
    s_or_b64 s[92:93], s[92:93], s[20:21]
    s_cbranch_scc0 Lok_11
Lre_12:
    s_add_u32 s94, s94, 1
    s_cmp_ge_u32 s94, 100000
    s_cbranch_scc1 Lok_11
    s_mov_b64 exec, s[12:13]
    s_cbranch_execz Lsk_13
    buffer_load_dwordx4 v[156:159], v37, s[60:63], s86 offen sc1
Lsk_13:
    s_mov_b64 exec, s[14:15]
    s_cbranch_execz Lsk_14
    buffer_load_dwordx4 v[160:163], v37, s[60:63], s86 offen offset:128 sc1
Lsk_14:
    s_mov_b64 exec, s[16:17]
    s_cbranch_execz Lsk_15
    buffer_load_dwordx4 v[148:151], v36, s[60:63], s85 offen sc1
Lsk_15:
    s_mov_b64 exec, s[18:19]
    s_cbranch_execz Lsk_16
    buffer_load_dwordx4 v[152:155], v36, s[60:63], s85 offen offset:2048 sc1
Lsk_16:
    s_mov_b64 exec, s[20:21]
    s_cbranch_execz Lsk_17
    buffer_load_dwordx4 v[164:167], v36, s[60:63], s87 offen sc1
Lsk_17:
    s_waitcnt vmcnt(0)
    s_mov_b64 exec, s[12:13]
    v_perm_b32 v45, v157, v156, s70
    v_perm_b32 v46, v159, v158, s71
    v_or_b32 v45, v45, v46
    v_cmp_ne_u32 s[12:13], s69, v45
    s_mov_b64 exec, s[14:15]
    v_perm_b32 v45, v161, v160, s70
    v_perm_b32 v46, v163, v162, s71
    v_or_b32 v45, v45, v46
    v_cmp_ne_u32 s[14:15], s69, v45
    s_mov_b64 exec, s[16:17]
    v_perm_b32 v45, v149, v148, s70
    v_perm_b32 v46, v151, v150, s71
    v_or_b32 v45, v45, v46
    v_cmp_ne_u32 s[16:17], s69, v45
    s_mov_b64 exec, s[18:19]
    v_perm_b32 v45, v153, v152, s70
    v_perm_b32 v46, v155, v154, s71
    v_or_b32 v45, v45, v46
    v_cmp_ne_u32 s[18:19], s69, v45
    s_mov_b64 exec, s[20:21]
    v_perm_b32 v45, v165, v164, s70
    v_perm_b32 v46, v167, v166, s71
    v_or_b32 v45, v45, v46
    v_cmp_ne_u32 s[20:21], s69, v45
    s_mov_b64 exec, -1
    s_or_b64 s[92:93], s[12:13], s[14:15]
    s_or_b64 s[92:93], s[92:93], s[16:17]
    s_or_b64 s[92:93], s[92:93], s[18:19]
    s_or_b64 s[92:93], s[92:93], s[20:21]
    s_cbranch_scc1 Lre_12
Lok_11:
    s_mov_b64 exec, -1
    v_and_b32 v156, 0xffffff00, v156
    v_and_b32 v157, 0xffffff00, v157
    v_and_b32 v160, 0xffffff00, v160
    v_and_b32 v161, 0xffffff00, v161
    v_and_b32 v148, 0xffffff00, v148
    v_and_b32 v149, 0xffffff00, v149
    v_and_b32 v150, 0xffffff00, v150
    v_and_b32 v151, 0xffffff00, v151
    v_and_b32 v152, 0xffffff00, v152
    v_and_b32 v153, 0xffffff00, v153
    v_and_b32 v154, 0xffffff00, v154
    v_and_b32 v155, 0xffffff00, v155
    v_and_b32 v164, 0xffffff00, v164
    v_and_b32 v165, 0xffffff00, v165
    v_and_b32 v166, 0xffffff00, v166
    v_and_b32 v167, 0xffffff00, v167
    v_max_f32 v232, v156, v160
    v_permlane16_swap_b32 v164, v165
    v_add_f32 v164, v164, v165
    v_permlane16_swap_b32 v166, v167
    v_add_f32 v166, v166, v167
    v_max_f32_dpp v232, v232, v232 row_ror:8 row_mask:0xf bank_mask:0xf
    v_mov_b32 v233, v232
    s_nop 1
    v_permlane16_swap_b32 v232, v233
    v_max_f32 v232, v232, v233
    v_mov_b32 v233, v232
    s_nop 1
    v_permlane32_swap_b32 v232, v233
    v_max_f32 v232, v232, v233
    v_add_f32_dpp v164, v164, v164 row_ror:8 row_mask:0xf bank_mask:0xf
    v_add_f32_dpp v166, v166, v166 row_ror:8 row_mask:0xf bank_mask:0xf
    v_sub_f32 v156, v156, v232
    v_sub_f32 v160, v160, v232
    v_mul_f32 v156, 0x3fb8aa3b, v156
    v_mul_f32 v160, 0x3fb8aa3b, v160
    v_exp_f32 v156, v156
    v_exp_f32 v160, v160
    v_cvt_pk_bf16_f32 v164, v164, v164
    v_and_b32 v164, 0xffff0000, v164
    v_cvt_pk_bf16_f32 v166, v166, v166
    v_and_b32 v166, 0xffff0000, v166
    v_mul_f32 v232, v156, v157
    v_pk_mul_f32 v[228:229], v[148:149], v[156:157] op_sel_hi:[1,0]
    v_pk_mul_f32 v[230:231], v[150:151], v[156:157] op_sel_hi:[1,0]
    v_fmac_f32 v232, v160, v161
    v_pk_fma_f32 v[228:229], v[152:153], v[160:161], v[228:229] op_sel_hi:[1,0,1]
    v_pk_fma_f32 v[230:231], v[154:155], v[160:161], v[230:231] op_sel_hi:[1,0,1]
    v_permlane32_swap_b32 v164, v166
    v_mul_f32 v164, v164, v166
    v_add_f32_dpp v232, v232, v232 row_ror:8 row_mask:0xf bank_mask:0xf
    v_mov_b32 v233, v232
    s_nop 1
    v_permlane16_swap_b32 v232, v233
    v_add_f32 v232, v232, v233
    v_mov_b32 v233, v232
    s_nop 1
    v_permlane32_swap_b32 v232, v233
    v_add_f32 v232, v232, v233
    v_permlane32_swap_b32 v228, v230
    v_add_f32 v228, v228, v230
    v_permlane32_swap_b32 v229, v231
    v_add_f32 v229, v229, v231
    v_rcp_f32 v232, v232
    s_nop 0
    v_permlane16_swap_b32 v228, v229
    v_add_f32 v228, v228, v229
    v_cvt_pk_bf16_f32 v164, v164, v164
    s_nop 0
    v_add_f32_dpp v228, v228, v228 row_ror:8 row_mask:0xf bank_mask:0xf
    ds_write_b32 v38, v164 offset:3968
    v_mul_f32 v228, v228, v232
    v_cvt_pk_bf16_f32 v228, v228, v228
    ds_write_b32 v38, v228 offset:2688
    s_waitcnt lgkmcnt(0)
    s_barrier
    ds_read_b128 v[204:207], v39 offset:2688
    ds_read_b128 v[208:211], v39 offset:3968
    s_waitcnt lgkmcnt(0)
    v_and_b32 v212, v204, v4
    v_and_b32 v213, v204, v5
    v_and_b32 v214, v205, v4
    v_and_b32 v215, v205, v5
    v_and_b32 v216, v206, v4
    v_and_b32 v217, v206, v5
    v_and_b32 v218, v207, v4
    v_and_b32 v219, v207, v5
    v_and_b32 v220, v208, v4
    v_and_b32 v221, v208, v5
    v_and_b32 v222, v209, v4
    v_and_b32 v223, v209, v5
    v_and_b32 v224, v210, v4
    v_and_b32 v225, v210, v5
    v_and_b32 v226, v211, v4
    v_and_b32 v227, v211, v5
    s_waitcnt vmcnt(15)
    v_mfma_f32_16x16x16_bf16 v[180:183], v[212:213], v[116:117], 0
    v_mfma_f32_16x16x16_bf16 v[184:187], v[212:213], v[118:119], 0
    s_waitcnt vmcnt(12)
    v_mfma_f32_16x16x16_bf16 v[180:183], v[214:215], v[120:121], v[180:183]
    v_mfma_f32_16x16x16_bf16 v[184:187], v[214:215], v[122:123], v[184:187]
    s_waitcnt vmcnt(10)
    v_mfma_f32_16x16x16_bf16 v[180:183], v[216:217], v[124:125], v[180:183]
    v_mfma_f32_16x16x16_bf16 v[184:187], v[216:217], v[126:127], v[184:187]
    s_waitcnt vmcnt(9)
    v_mfma_f32_16x16x16_bf16 v[180:183], v[218:219], v[128:129], v[180:183]
    v_mfma_f32_16x16x16_bf16 v[184:187], v[218:219], v[130:131], v[184:187]
    s_waitcnt vmcnt(8)
    v_mfma_f32_16x16x16_bf16 v[180:183], v[220:221], v[132:133], v[180:183]
    v_mfma_f32_16x16x16_bf16 v[184:187], v[220:221], v[134:135], v[184:187]
    s_waitcnt vmcnt(7)
    v_mfma_f32_16x16x16_bf16 v[180:183], v[222:223], v[136:137], v[180:183]
    v_mfma_f32_16x16x16_bf16 v[184:187], v[222:223], v[138:139], v[184:187]
    s_waitcnt vmcnt(6)
    v_mfma_f32_16x16x16_bf16 v[180:183], v[224:225], v[140:141], v[180:183]
    v_mfma_f32_16x16x16_bf16 v[184:187], v[224:225], v[142:143], v[184:187]
    s_waitcnt vmcnt(0)
    v_mfma_f32_16x16x16_bf16 v[180:183], v[226:227], v[144:145], v[180:183]
    v_mfma_f32_16x16x16_bf16 v[184:187], v[226:227], v[146:147], v[184:187]
    s_nop 6
    ds_write_b128 v17, v[180:183]
    ds_write_b128 v17, v[184:187] offset:16
    s_waitcnt lgkmcnt(0)
    s_barrier
    s_cmp_lt_u32 s3, 4
    s_cbranch_scc1 Lx_19
    ds_read_b128 v[148:151], v19
    ds_read_b128 v[152:155], v19 offset:4096
    ds_read_b128 v[156:159], v19 offset:8192
    ds_read_b128 v[160:163], v19 offset:12288
    s_waitcnt lgkmcnt(2)
    v_pk_add_f32 v[148:149], v[148:149], v[152:153]
    v_pk_add_f32 v[150:151], v[150:151], v[154:155]
    s_waitcnt lgkmcnt(0)
    v_pk_add_f32 v[156:157], v[156:157], v[160:161]
    v_pk_add_f32 v[158:159], v[158:159], v[162:163]
    v_pk_add_f32 v[228:229], v[148:149], v[156:157]
    v_pk_add_f32 v[230:231], v[150:151], v[158:159]
    v_add_u32 v228, 0x80, v228
    v_add_u32 v229, 0x80, v229
    v_add_u32 v230, 0x80, v230
    v_add_u32 v231, 0x80, v231
    v_bfi_b32 v228, v6, s65, v228
    v_bfi_b32 v229, v6, s66, v229
    v_bfi_b32 v230, v6, s67, v230
    v_bfi_b32 v231, v6, s68, v231
    buffer_store_dwordx4 v[228:231], v40, s[60:63], s88 offen sc1
    s_cmp_lg_u32 s3, 7
    s_nop 0
    s_cbranch_scc1 Lx_19
    s_waitcnt vmcnt(0)
    s_branch Lfin_18
Lx_19:
    s_endpgm
Lfin_18:
    buffer_load_dwordx4 v[148:151], v20, s[60:63], s89 offen sc1
    buffer_load_dwordx4 v[152:155], v20, s[60:63], s89 offen offset:1024 sc1
    buffer_load_dwordx4 v[156:159], v20, s[60:63], s89 offen offset:2048 sc1
    buffer_load_dwordx4 v[160:163], v20, s[60:63], s89 offen offset:3072 sc1
    s_waitcnt vmcnt(3)
    v_perm_b32 v45, v149, v148, s70
    v_perm_b32 v46, v151, v150, s71
    v_or_b32 v45, v45, v46
    v_cmp_ne_u32 s[12:13], s69, v45
    s_waitcnt vmcnt(2)
    v_perm_b32 v45, v153, v152, s70
    v_perm_b32 v46, v155, v154, s71
    v_or_b32 v45, v45, v46
    v_cmp_ne_u32 s[14:15], s69, v45
    s_waitcnt vmcnt(1)
    v_perm_b32 v45, v157, v156, s70
    v_perm_b32 v46, v159, v158, s71
    v_or_b32 v45, v45, v46
    v_cmp_ne_u32 s[16:17], s69, v45
    s_waitcnt vmcnt(0)
    v_perm_b32 v45, v161, v160, s70
    v_perm_b32 v46, v163, v162, s71
    v_or_b32 v45, v45, v46
    v_cmp_ne_u32 s[18:19], s69, v45
    s_mov_b32 s94, 0
    s_or_b64 s[92:93], s[12:13], s[14:15]
    s_or_b64 s[92:93], s[92:93], s[16:17]
    s_or_b64 s[92:93], s[92:93], s[18:19]
    s_nop 0
    s_cbranch_scc0 Lok_20
Lre_21:
    s_add_u32 s94, s94, 1
    s_cmp_ge_u32 s94, 100000
    s_cbranch_scc1 Lok_20
    s_mov_b64 exec, s[12:13]
    s_cbranch_execz Lsk_22
    buffer_load_dwordx4 v[148:151], v20, s[60:63], s89 offen sc1
Lsk_22:
    s_mov_b64 exec, s[14:15]
    s_cbranch_execz Lsk_23
    buffer_load_dwordx4 v[152:155], v20, s[60:63], s89 offen offset:1024 sc1
Lsk_23:
    s_mov_b64 exec, s[16:17]
    s_cbranch_execz Lsk_24
    buffer_load_dwordx4 v[156:159], v20, s[60:63], s89 offen offset:2048 sc1
Lsk_24:
    s_mov_b64 exec, s[18:19]
    s_cbranch_execz Lsk_25
    buffer_load_dwordx4 v[160:163], v20, s[60:63], s89 offen offset:3072 sc1
Lsk_25:
    s_waitcnt vmcnt(0)
    s_mov_b64 exec, s[12:13]
    v_perm_b32 v45, v149, v148, s70
    v_perm_b32 v46, v151, v150, s71
    v_or_b32 v45, v45, v46
    v_cmp_ne_u32 s[12:13], s69, v45
    s_mov_b64 exec, s[14:15]
    v_perm_b32 v45, v153, v152, s70
    v_perm_b32 v46, v155, v154, s71
    v_or_b32 v45, v45, v46
    v_cmp_ne_u32 s[14:15], s69, v45
    s_mov_b64 exec, s[16:17]
    v_perm_b32 v45, v157, v156, s70
    v_perm_b32 v46, v159, v158, s71
    v_or_b32 v45, v45, v46
    v_cmp_ne_u32 s[16:17], s69, v45
    s_mov_b64 exec, s[18:19]
    v_perm_b32 v45, v161, v160, s70
    v_perm_b32 v46, v163, v162, s71
    v_or_b32 v45, v45, v46
    v_cmp_ne_u32 s[18:19], s69, v45
    s_mov_b64 exec, -1
    s_or_b64 s[92:93], s[12:13], s[14:15]
    s_or_b64 s[92:93], s[92:93], s[16:17]
    s_or_b64 s[92:93], s[92:93], s[18:19]
    s_nop 0
    s_cbranch_scc1 Lre_21
Lok_20:
    s_mov_b64 exec, -1
    v_and_b32 v148, 0xffffff00, v148
    v_and_b32 v149, 0xffffff00, v149
    v_and_b32 v150, 0xffffff00, v150
    v_and_b32 v151, 0xffffff00, v151
    v_and_b32 v152, 0xffffff00, v152
    v_and_b32 v153, 0xffffff00, v153
    v_and_b32 v154, 0xffffff00, v154
    v_and_b32 v155, 0xffffff00, v155
    v_and_b32 v156, 0xffffff00, v156
    v_and_b32 v157, 0xffffff00, v157
    v_and_b32 v158, 0xffffff00, v158
    v_and_b32 v159, 0xffffff00, v159
    v_and_b32 v160, 0xffffff00, v160
    v_and_b32 v161, 0xffffff00, v161
    v_and_b32 v162, 0xffffff00, v162
    v_and_b32 v163, 0xffffff00, v163
    v_pk_add_f32 v[148:149], v[148:149], v[152:153]
    v_pk_add_f32 v[156:157], v[156:157], v[160:161]
    v_pk_add_f32 v[150:151], v[150:151], v[154:155]
    v_pk_add_f32 v[158:159], v[158:159], v[162:163]
    v_pk_add_f32 v[148:149], v[148:149], v[156:157]
    v_pk_add_f32 v[150:151], v[150:151], v[158:159]
    s_nop 1
    v_permlane32_swap_b32 v148, v150
    v_add_f32 v148, v148, v150
    v_permlane32_swap_b32 v149, v151
    v_add_f32 v149, v149, v151
    s_nop 1
    v_permlane16_swap_b32 v148, v149
    v_add_f32 v148, v148, v149
    v_lshlrev_b32 v44, 16, v44
    s_nop 0
    v_add_f32_dpp v148, v148, v148 row_ror:4 row_mask:0xf bank_mask:0xf
    s_nop 1
    v_add_f32_dpp v148, v148, v148 row_ror:8 row_mask:0xf bank_mask:0xf
    v_add_f32 v148, v148, v44
    v_cvt_pk_bf16_f32 v148, v148, v148
    s_mov_b32 exec_lo, 0x000f000f
    s_mov_b32 exec_hi, 0x000f000f
    buffer_store_short v148, v41, s[56:59], s90 offen
    s_cmp_lg_u32 s2, 0
    s_nop 0
    s_cbranch_scc1 Lne_26
    s_add_u32 s96, s64, 1
    s_mov_b64 exec, 1
    v_mov_b32 v48, s96
    buffer_store_dword v48, off, s[60:63], 0 sc1
    s_nop 1
Lne_26:
    s_mov_b64 exec, -1
    s_endpgm
L_nogu:
    s_lshl_b32 s76, s76, 6
    v_lshrrev_b32 v45, 2, v2
    v_mul_u32_u24 v46, 4160, v45
    v_lshl_add_u32 v15, v3, 4, v46
    v_add_u32 v15, s76, v15
    s_lshr_b32 s95, s3, 1
    s_and_b32 s97, s3, 1
    s_and_b32 s76, s2, 7
    s_lshr_b32 s77, s2, 7
    s_lshl3_add_u32 s76, s77, s76
    s_bfe_u32 s77, s2, 0x40003
    s_lshl_b32 s73, s76, 9
    s_lshl3_add_u32 s96, s77, s3
    s_add_u32 s73, s73, s96
    s_add_u32 s73, s73, 384
    s_lshl_b32 s73, s73, 12
    v_xor_b32 v47, v2, v3
    v_lshlrev_b32 v47, 4, v47
    v_lshl_add_u32 v11, v3, 8, v47
    v_xor_b32 v12, 64, v11
    v_xor_b32 v13, 0x80, v11
    v_xor_b32 v14, 0xc0, v11
    s_mov_b32 s32, s6
    s_mov_b32 s33, s7
    s_mov_b32 s34, 33554432
    s_mov_b32 s35, 0x00020000
    s_mov_b32 s36, s8
    s_mov_b32 s37, s9
    s_mov_b32 s38, 33554432
    s_mov_b32 s39, 0x00020000
    s_lshl_b32 s91, s3, 12
    s_add_u32 s91, s91, 46592
    s_mov_b32 m0, s91
    v_lshl_add_u32 v10, v3, 10, v21
    v_lshl_add_u32 v23, v2, 8, v47
    v_add_u32 v23, s91, v23
    v_and_b32 v45, 3, v1
    v_and_b32 v46, 1, v1
    v_lshlrev_b32 v46, 4, v46
    v_mov_b32 v47, 0xffff
    v_lshlrev_b32 v47, v46, v47
    v_cmp_gt_u32 vcc, 2, v45
    v_mov_b32 v6, 0xff
    s_nop 0
    v_cndmask_b32 v4, 0, v47, vcc
    v_cndmask_b32 v5, v47, 0, vcc
    s_lshl_b32 s78, s3, 11
    s_add_u32 s78, s78, 30208
    v_lshlrev_b32 v48, 5, v2
    v_lshl_add_u32 v48, v3, 9, v48
    v_add_u32 v17, s78, v48
    v_add_u32 v32, s91, v48
    s_lshl_b32 s78, s3, 8
    s_add_u32 s78, s78, 30208
    v_add_u32 v18, s78, v21
    s_lshl_b32 s78, s95, 8
    s_add_u32 s78, s78, s2
    s_lshl1_add_u32 s78, s78, s97
    s_lshl_b32 s80, s78, 8
    s_add_u32 s80, s80, 1048576
    buffer_load_dwordx4 v11, s[32:35], s73 offen nt lds
    s_cmp_ge_u32 s3, 4
    s_cbranch_scc1 Ldef_27
    s_mul_i32 s78, s3, 4160
    v_lshlrev_b32 v48, 1, v20
    v_add_u32 v48, s78, v48
    s_waitcnt vmcnt(6)
    v_lshlrev_b32 v212, 16, v148
    v_and_b32 v213, 0xffff0000, v148
    v_lshlrev_b32 v214, 16, v149
    v_and_b32 v215, 0xffff0000, v149
    v_lshlrev_b32 v216, 16, v150
    v_and_b32 v217, 0xffff0000, v150
    v_lshlrev_b32 v218, 16, v151
    v_and_b32 v219, 0xffff0000, v151
    v_lshlrev_b32 v220, 16, v152
    v_and_b32 v221, 0xffff0000, v152
    v_lshlrev_b32 v222, 16, v153
    v_and_b32 v223, 0xffff0000, v153
    v_lshlrev_b32 v224, 16, v154
    v_and_b32 v225, 0xffff0000, v154
    v_lshlrev_b32 v226, 16, v155
    v_and_b32 v227, 0xffff0000, v155
    v_readfirstlane_b32 s100, v212
    s_nop 1
    v_pk_add_f32 v[156:157], v[212:213], s[100:101] op_sel_hi:[1,0] neg_lo:[0,1] neg_hi:[0,1]
    v_pk_add_f32 v[158:159], v[214:215], s[100:101] op_sel_hi:[1,0] neg_lo:[0,1] neg_hi:[0,1]
    v_pk_add_f32 v[160:161], v[216:217], s[100:101] op_sel_hi:[1,0] neg_lo:[0,1] neg_hi:[0,1]
    v_pk_add_f32 v[162:163], v[218:219], s[100:101] op_sel_hi:[1,0] neg_lo:[0,1] neg_hi:[0,1]
    v_pk_add_f32 v[164:165], v[220:221], s[100:101] op_sel_hi:[1,0] neg_lo:[0,1] neg_hi:[0,1]
    v_pk_add_f32 v[166:167], v[222:223], s[100:101] op_sel_hi:[1,0] neg_lo:[0,1] neg_hi:[0,1]
    v_pk_add_f32 v[168:169], v[224:225], s[100:101] op_sel_hi:[1,0] neg_lo:[0,1] neg_hi:[0,1]
    v_pk_add_f32 v[170:171], v[226:227], s[100:101] op_sel_hi:[1,0] neg_lo:[0,1] neg_hi:[0,1]
    v_pk_add_f32 v[228:229], v[156:157], v[158:159]
    v_pk_add_f32 v[230:231], v[160:161], v[162:163]
    v_pk_add_f32 v[232:233], v[164:165], v[166:167]
    v_pk_add_f32 v[234:235], v[168:169], v[170:171]
    v_pk_mul_f32 v[236:237], v[156:157], v[156:157]
    v_pk_mul_f32 v[238:239], v[158:159], v[158:159]
    v_pk_add_f32 v[228:229], v[228:229], v[230:231]
    v_pk_add_f32 v[232:233], v[232:233], v[234:235]
    v_pk_fma_f32 v[236:237], v[160:161], v[160:161], v[236:237]
    v_pk_fma_f32 v[238:239], v[162:163], v[162:163], v[238:239]
    v_pk_fma_f32 v[236:237], v[164:165], v[164:165], v[236:237]
    v_pk_fma_f32 v[238:239], v[166:167], v[166:167], v[238:239]
    v_pk_fma_f32 v[236:237], v[168:169], v[168:169], v[236:237]
    v_pk_fma_f32 v[238:239], v[170:171], v[170:171], v[238:239]
    v_pk_add_f32 v[228:229], v[228:229], v[232:233]
    v_pk_add_f32 v[236:237], v[236:237], v[238:239]
    v_add_f32 v228, v228, v229
    v_add_f32 v236, v236, v237
    s_nop 0
    v_add_f32_dpp v228, v228, v228 row_ror:8 row_mask:0xf bank_mask:0xf
    v_add_f32_dpp v236, v236, v236 row_ror:8 row_mask:0xf bank_mask:0xf
    s_nop 0
    v_add_f32_dpp v228, v228, v228 row_ror:4 row_mask:0xf bank_mask:0xf
    v_add_f32_dpp v236, v236, v236 row_ror:4 row_mask:0xf bank_mask:0xf
    s_nop 0
    v_add_f32_dpp v228, v228, v228 row_ror:2 row_mask:0xf bank_mask:0xf
    v_add_f32_dpp v236, v236, v236 row_ror:2 row_mask:0xf bank_mask:0xf
    s_nop 0
    v_add_f32_dpp v228, v228, v228 row_ror:1 row_mask:0xf bank_mask:0xf
    v_add_f32_dpp v236, v236, v236 row_ror:1 row_mask:0xf bank_mask:0xf
    s_nop 0
    v_add_f32_dpp v228, v228, v228 row_bcast:15 row_mask:0xa bank_mask:0xf
    v_add_f32_dpp v236, v236, v236 row_bcast:15 row_mask:0xa bank_mask:0xf
    s_nop 0
    v_add_f32_dpp v228, v228, v228 row_bcast:31 row_mask:0xc bank_mask:0xf
    v_add_f32_dpp v236, v236, v236 row_bcast:31 row_mask:0xc bank_mask:0xf
    v_readlane_b32 s78, v228, 63
    v_readlane_b32 s79, v236, 63
    v_mov_b32 v45, 0x3a800000
    v_mul_f32 v46, s78, v45
    v_mul_f32 v232, s79, v45
    v_add_f32 v230, s100, v46
    v_fma_f32 v232, -v46, v46, v232
    v_max_f32 v232, 0, v232
    v_cvt_pk_bf16_f32 v230, v230, v230
    v_and_b32 v230, 0xffff0000, v230
    v_cvt_pk_bf16_f32 v232, v232, v232
    v_and_b32 v232, 0xffff0000, v232
    v_add_f32 v232, 0x3727c5ac, v232
    v_pk_add_f32 v[212:213], v[212:213], v[230:231] op_sel_hi:[1,0] neg_lo:[0,1] neg_hi:[0,1]
    v_pk_add_f32 v[214:215], v[214:215], v[230:231] op_sel_hi:[1,0] neg_lo:[0,1] neg_hi:[0,1]
    v_pk_add_f32 v[216:217], v[216:217], v[230:231] op_sel_hi:[1,0] neg_lo:[0,1] neg_hi:[0,1]
    v_pk_add_f32 v[218:219], v[218:219], v[230:231] op_sel_hi:[1,0] neg_lo:[0,1] neg_hi:[0,1]
    v_pk_add_f32 v[220:221], v[220:221], v[230:231] op_sel_hi:[1,0] neg_lo:[0,1] neg_hi:[0,1]
    v_pk_add_f32 v[222:223], v[222:223], v[230:231] op_sel_hi:[1,0] neg_lo:[0,1] neg_hi:[0,1]
    v_pk_add_f32 v[224:225], v[224:225], v[230:231] op_sel_hi:[1,0] neg_lo:[0,1] neg_hi:[0,1]
    v_pk_add_f32 v[226:227], v[226:227], v[230:231] op_sel_hi:[1,0] neg_lo:[0,1] neg_hi:[0,1]
    v_cvt_pk_bf16_f32 v232, v232, v232
    v_and_b32 v232, 0xffff0000, v232
    v_sqrt_f32 v232, v232
    v_cvt_pk_bf16_f32 v156, v212, v213
    v_cvt_pk_bf16_f32 v157, v214, v215
    v_cvt_pk_bf16_f32 v158, v216, v217
    v_cvt_pk_bf16_f32 v159, v218, v219
    v_cvt_pk_bf16_f32 v160, v220, v221
    v_cvt_pk_bf16_f32 v161, v222, v223
    v_cvt_pk_bf16_f32 v162, v224, v225
    v_cvt_pk_bf16_f32 v163, v226, v227
    v_cvt_pk_bf16_f32 v232, v232, v232
    v_and_b32 v232, 0xffff0000, v232
    v_rcp_f32 v234, v232
    v_lshlrev_b32 v212, 16, v156
    v_and_b32 v213, 0xffff0000, v156
    v_lshlrev_b32 v214, 16, v157
    v_and_b32 v215, 0xffff0000, v157
    v_lshlrev_b32 v216, 16, v158
    v_and_b32 v217, 0xffff0000, v158
    v_lshlrev_b32 v218, 16, v159
    v_and_b32 v219, 0xffff0000, v159
    v_lshlrev_b32 v220, 16, v160
    v_and_b32 v221, 0xffff0000, v160
    v_lshlrev_b32 v222, 16, v161
    v_and_b32 v223, 0xffff0000, v161
    v_lshlrev_b32 v224, 16, v162
    v_and_b32 v225, 0xffff0000, v162
    v_lshlrev_b32 v226, 16, v163
    v_and_b32 v227, 0xffff0000, v163
    v_pk_mul_f32 v[212:213], v[212:213], v[234:235] op_sel_hi:[1,0]
    v_pk_mul_f32 v[214:215], v[214:215], v[234:235] op_sel_hi:[1,0]
    v_pk_mul_f32 v[216:217], v[216:217], v[234:235] op_sel_hi:[1,0]
    v_pk_mul_f32 v[218:219], v[218:219], v[234:235] op_sel_hi:[1,0]
    v_pk_mul_f32 v[220:221], v[220:221], v[234:235] op_sel_hi:[1,0]
    v_pk_mul_f32 v[222:223], v[222:223], v[234:235] op_sel_hi:[1,0]
    v_pk_mul_f32 v[224:225], v[224:225], v[234:235] op_sel_hi:[1,0]
    v_pk_mul_f32 v[226:227], v[226:227], v[234:235] op_sel_hi:[1,0]
    v_cvt_pk_bf16_f32 v156, v212, v212
    v_cvt_pk_bf16_f32 v157, v213, v213
    v_cvt_pk_bf16_f32 v158, v214, v214
    v_cvt_pk_bf16_f32 v159, v215, v215
    ds_write_b128 v48, v[156:159] offset:13568
    v_cvt_pk_bf16_f32 v160, v216, v216
    v_cvt_pk_bf16_f32 v161, v217, v217
    v_cvt_pk_bf16_f32 v162, v218, v218
    v_cvt_pk_bf16_f32 v163, v219, v219
    ds_write_b128 v48, v[160:163] offset:13584
    v_cvt_pk_bf16_f32 v164, v220, v220
    v_cvt_pk_bf16_f32 v165, v221, v221
    v_cvt_pk_bf16_f32 v166, v222, v222
    v_cvt_pk_bf16_f32 v167, v223, v223
    ds_write_b128 v48, v[164:167] offset:15616
    v_cvt_pk_bf16_f32 v168, v224, v224
    v_cvt_pk_bf16_f32 v169, v225, v225
    v_cvt_pk_bf16_f32 v170, v226, v226
    v_cvt_pk_bf16_f32 v171, v227, v227
    ds_write_b128 v48, v[168:171] offset:15632
    s_nop 0
    s_branch Lb1_28
Ldef_27:
    s_mov_b32 s70, 0x0c0c0400
    s_mov_b32 s71, 0x04000c0c
    s_lshl3_add_u32 s78, s76, s3
    s_lshl_b32 s81, s78, 12
    s_add_u32 s81, s81, 1048576
    s_and_b32 s78, s76, 3
    s_lshl3_add_u32 s78, s78, s3
    s_lshr_b32 s79, s76, 2
    s_lshl3_add_u32 s96, s78, s79
    s_lshl4_add_u32 s96, s96, s77
    s_lshl_b32 s82, s96, 8
    s_add_u32 s82, s82, 2097152
    s_lshl2_add_u32 s96, s78, s79
    s_lshl4_add_u32 s96, s96, s77
    s_lshl_b32 s83, s96, 4
    s_add_u32 s83, s83, 3145728
    s_and_b32 s78, s2, 7
    s_lshr_b32 s79, s2, 5
    s_lshl3_add_u32 s78, s79, s78
    s_bfe_u32 s79, s2, 0x20003
    s_bfe_u32 s96, s2, 0x10004
    s_xor_b32 s96, s96, 1
    s_and_b32 s79, s79, 1
    s_lshl1_add_u32 s79, s79, s96
    s_lshl2_add_u32 s76, s78, s95
    s_lshl_b32 s75, s76, 15
    s_lshl1_add_u32 s96, s79, s97
    s_lshl_b32 s96, s96, 8
    s_add_u32 s75, s75, s96
    s_lshl_b32 s77, s97, 7
    s_lshl_b32 s85, s76, 12
    s_add_u32 s85, s85, s77
    s_add_u32 s85, s85, 2097152
    s_lshr_b32 s96, s78, 1
    s_lshl2_add_u32 s96, s96, s95
    s_lshl_b32 s86, s96, 8
    s_add_u32 s86, s86, 3145728
    s_and_b32 s96, s3, 3
    s_lshl2_add_u32 s96, s79, s96
    s_lshl_b32 s88, s96, 16
    s_lshl_b32 s96, s78, 6
    s_add_u32 s88, s88, s96
    s_add_u32 s88, s88, 5242880
    s_mov_b32 s44, s12
    s_mov_b32 s45, s13
    s_mov_b32 s46, 8388608
    s_mov_b32 s47, 0x00020000
    s_mov_b32 s56, s22
    s_mov_b32 s57, s23
    s_mov_b32 s58, 8192
    s_mov_b32 s59, 0x00020000
    v_lshl_add_u32 v9, v3, 13, v21
    v_and_b32 v22, 31, v1
    v_lshlrev_b32 v22, 4, v22
    v_xor_b32 v24, 64, v23
    v_xor_b32 v25, 0x80, v23
    v_xor_b32 v26, 0xc0, v23
    v_and_b32 v45, 7, v1
    v_mul_u32_u24 v27, 272, v45
    v_lshl_add_u32 v27, v3, 4, v27
    s_mul_i32 s96, s3, 272
    v_lshrrev_b32 v28, 1, v22
    v_lshrrev_b32 v46, 5, v1
    v_lshl_add_u32 v28, v46, 2, v28
    v_add_u32 v28, s96, v28
    s_lshl_b32 s96, s3, 10
    v_lshlrev_b32 v46, 4, v3
    v_lshl_add_u32 v29, v2, 6, v46
    v_add_u32 v29, s96, v29
    v_lshrrev_b32 v47, 2, v2
    v_lshl_add_u32 v30, v47, 6, v46
    v_add_u32 v30, s96, v30
    v_mul_u32_u24 v39, 320, v47
    v_add_u32 v39, v39, v46
    s_lshl_b32 s96, s95, 6
    v_add_u32 v39, s96, v39
    s_lshl_b32 s96, s3, 3
    v_lshlrev_b32 v31, 6, v2
    v_add_u32 v31, s96, v31
    s_lshl_b32 s96, s3, 6
    v_lshlrev_b32 v33, 3, v45
    v_add_u32 v33, s96, v33
    s_lshl_b32 s96, s3, 9
    s_add_u32 s96, s96, 46592
    v_add_u32 v34, s96, v22
    v_and_b32 v35, 16, v1
    v_lshl_add_u32 v35, v35, 10, v21
    v_lshrrev_b32 v46, 3, v1
    v_lshlrev_b32 v45, 4, v45
    v_lshl_add_u32 v36, v46, 8, v45
    v_lshlrev_b32 v37, 4, v46
    s_mul_i32 s96, s95, 320
    s_add_u32 s96, s96, s77
    v_lshl_add_u32 v38, v3, 2, v45
    v_add_u32 v38, s96, v38
    s_and_b32 s96, s3, 3
    s_lshl_b32 s96, s96, 9
    s_add_u32 s96, s96, 30208
    v_lshrrev_b32 v46, 5, v1
    v_lshl_add_u32 v19, v46, 11, v22
    v_add_u32 v19, s96, v19
    v_and_b32 v45, 3, v1
    v_lshrrev_b32 v46, 2, v1
    v_lshlrev_b32 v40, 4, v45
    v_lshl_add_u32 v40, v46, 12, v40
    s_bfe_u32 s96, s2, 0x20004
    s_lshr_b32 s89, s2, 6
    s_lshl2_add_u32 s96, s96, s89
    s_and_b32 s89, s2, 15
    s_lshl4_add_u32 s96, s96, s89
    s_lshl_b32 s89, s96, 12
    s_add_u32 s89, s89, 5242880
Lb1_28:
    s_waitcnt lgkmcnt(0)
    s_barrier
    ds_read_b128 v[204:207], v15 offset:13568
    s_waitcnt lgkmcnt(0)
    v_and_b32 v212, v204, v4
    v_and_b32 v213, v204, v5
    v_and_b32 v214, v205, v4
    v_and_b32 v215, v205, v5
    v_and_b32 v216, v206, v4
    v_and_b32 v217, v206, v5
    v_and_b32 v218, v207, v4
    v_and_b32 v219, v207, v5
    s_waitcnt vmcnt(5)
    buffer_load_dwordx4 v12, s[32:35], s73 offen offset:1024 nt lds
    v_mfma_f32_16x16x16_bf16 v[180:183], v[212:213], v[52:53], 0
    v_mfma_f32_16x16x16_bf16 v[184:187], v[212:213], v[54:55], 0
    s_waitcnt vmcnt(5)
    buffer_load_dwordx4 v13, s[32:35], s73 offen offset:2048 nt lds
    v_mfma_f32_16x16x16_bf16 v[180:183], v[214:215], v[56:57], v[180:183]
    v_mfma_f32_16x16x16_bf16 v[184:187], v[214:215], v[58:59], v[184:187]
    s_waitcnt vmcnt(5)
    buffer_load_dwordx4 v14, s[32:35], s73 offen offset:3072 nt lds
    v_mfma_f32_16x16x16_bf16 v[180:183], v[216:217], v[60:61], v[180:183]
    v_mfma_f32_16x16x16_bf16 v[184:187], v[216:217], v[62:63], v[184:187]
    s_waitcnt vmcnt(5)
    buffer_load_dwordx4 v[68:71], v10, s[36:39], s73 offen nt
    v_mfma_f32_16x16x16_bf16 v[180:183], v[218:219], v[64:65], v[180:183]
    v_mfma_f32_16x16x16_bf16 v[184:187], v[218:219], v[66:67], v[184:187]
    s_add_u32 s65, s64, 17
    s_and_b32 s65, s65, 0xff
    s_add_u32 s66, s64, 74
    s_and_b32 s66, s66, 0xff
    s_add_u32 s67, s64, 199
    s_and_b32 s67, s67, 0xff
    s_add_u32 s68, s64, 142
    s_and_b32 s68, s68, 0xff
    ds_write_b128 v17, v[180:183]
    ds_write_b128 v17, v[184:187] offset:16
    s_waitcnt lgkmcnt(0)
    s_barrier
    ds_read_b128 v[148:151], v18
    ds_read_b128 v[152:155], v18 offset:2048
    ds_read_b128 v[156:159], v18 offset:4096
    ds_read_b128 v[160:163], v18 offset:6144
    ds_read_b128 v[164:167], v18 offset:8192
    ds_read_b128 v[168:171], v18 offset:10240
    ds_read_b128 v[172:175], v18 offset:12288
    ds_read_b128 v[176:179], v18 offset:14336
    s_waitcnt lgkmcnt(6)
    v_pk_add_f32 v[148:149], v[148:149], v[152:153]
    v_pk_add_f32 v[150:151], v[150:151], v[154:155]
    s_waitcnt lgkmcnt(4)
    v_pk_add_f32 v[156:157], v[156:157], v[160:161]
    v_pk_add_f32 v[158:159], v[158:159], v[162:163]
    s_waitcnt lgkmcnt(2)
    v_pk_add_f32 v[164:165], v[164:165], v[168:169]
    v_pk_add_f32 v[166:167], v[166:167], v[170:171]
    s_waitcnt lgkmcnt(0)
    v_pk_add_f32 v[172:173], v[172:173], v[176:177]
    v_pk_add_f32 v[174:175], v[174:175], v[178:179]
    v_pk_add_f32 v[148:149], v[148:149], v[156:157]
    v_pk_add_f32 v[150:151], v[150:151], v[158:159]
    v_pk_add_f32 v[164:165], v[164:165], v[172:173]
    v_pk_add_f32 v[166:167], v[166:167], v[174:175]
    v_pk_add_f32 v[228:229], v[148:149], v[164:165]
    v_pk_add_f32 v[230:231], v[150:151], v[166:167]
    v_add_u32 v228, 0x80, v228
    v_add_u32 v229, 0x80, v229
    v_add_u32 v230, 0x80, v230
    v_add_u32 v231, 0x80, v231
    v_bfi_b32 v228, v6, s65, v228
    v_bfi_b32 v229, v6, s66, v229
    v_bfi_b32 v230, v6, s67, v230
    v_bfi_b32 v231, v6, s68, v231
    s_mov_b64 exec, 0xffff
    buffer_store_dwordx4 v[228:231], v21, s[60:63], s80 offen sc1
    s_mov_b64 exec, -1
    s_lshl_b32 s96, s66, 8
    s_or_b32 s69, s65, s96
    s_lshl_b32 s96, s67, 16
    s_or_b32 s69, s69, s96
    s_lshl_b32 s96, s68, 24
    s_or_b32 s69, s69, s96
    s_cmp_ge_u32 s3, 4
    s_cbranch_scc1 Lskipdef_29
    s_mov_b32 s70, 0x0c0c0400
    s_mov_b32 s71, 0x04000c0c
    s_lshl3_add_u32 s78, s76, s3
    s_lshl_b32 s81, s78, 12
    s_add_u32 s81, s81, 1048576
    s_and_b32 s78, s76, 3
    s_lshl3_add_u32 s78, s78, s3
    s_lshr_b32 s79, s76, 2
    s_lshl3_add_u32 s96, s78, s79
    s_lshl4_add_u32 s96, s96, s77
    s_lshl_b32 s82, s96, 8
    s_add_u32 s82, s82, 2097152
    s_lshl2_add_u32 s96, s78, s79
    s_lshl4_add_u32 s96, s96, s77
    s_lshl_b32 s83, s96, 4
    s_add_u32 s83, s83, 3145728
    s_and_b32 s78, s2, 7
    s_lshr_b32 s79, s2, 5
    s_lshl3_add_u32 s78, s79, s78
    s_bfe_u32 s79, s2, 0x20003
    s_bfe_u32 s96, s2, 0x10004
    s_xor_b32 s96, s96, 1
    s_and_b32 s79, s79, 1
    s_lshl1_add_u32 s79, s79, s96
    s_lshl2_add_u32 s76, s78, s95
    s_lshl_b32 s75, s76, 15
    s_lshl1_add_u32 s96, s79, s97
    s_lshl_b32 s96, s96, 8
    s_add_u32 s75, s75, s96
    s_lshl_b32 s77, s97, 7
    s_lshl_b32 s85, s76, 12
    s_add_u32 s85, s85, s77
    s_add_u32 s85, s85, 2097152
    s_lshr_b32 s96, s78, 1
    s_lshl2_add_u32 s96, s96, s95
    s_lshl_b32 s86, s96, 8
    s_add_u32 s86, s86, 3145728
    s_and_b32 s96, s3, 3
    s_lshl2_add_u32 s96, s79, s96
    s_lshl_b32 s88, s96, 16
    s_lshl_b32 s96, s78, 6
    s_add_u32 s88, s88, s96
    s_add_u32 s88, s88, 5242880
    s_mov_b32 s44, s12
    s_mov_b32 s45, s13
    s_mov_b32 s46, 8388608
    s_mov_b32 s47, 0x00020000
    s_mov_b32 s56, s22
    s_mov_b32 s57, s23
    s_mov_b32 s58, 8192
    s_mov_b32 s59, 0x00020000
    v_lshl_add_u32 v9, v3, 13, v21
    v_and_b32 v22, 31, v1
    v_lshlrev_b32 v22, 4, v22
    v_xor_b32 v24, 64, v23
    v_xor_b32 v25, 0x80, v23
    v_xor_b32 v26, 0xc0, v23
    v_and_b32 v45, 7, v1
    v_mul_u32_u24 v27, 272, v45
    v_lshl_add_u32 v27, v3, 4, v27
    s_mul_i32 s96, s3, 272
    v_lshrrev_b32 v28, 1, v22
    v_lshrrev_b32 v46, 5, v1
    v_lshl_add_u32 v28, v46, 2, v28
    v_add_u32 v28, s96, v28
    s_lshl_b32 s96, s3, 10
    v_lshlrev_b32 v46, 4, v3
    v_lshl_add_u32 v29, v2, 6, v46
    v_add_u32 v29, s96, v29
    v_lshrrev_b32 v47, 2, v2
    v_lshl_add_u32 v30, v47, 6, v46
    v_add_u32 v30, s96, v30
    v_mul_u32_u24 v39, 320, v47
    v_add_u32 v39, v39, v46
    s_lshl_b32 s96, s95, 6
    v_add_u32 v39, s96, v39
    s_lshl_b32 s96, s3, 3
    v_lshlrev_b32 v31, 6, v2
    v_add_u32 v31, s96, v31
    s_lshl_b32 s96, s3, 6
    v_lshlrev_b32 v33, 3, v45
    v_add_u32 v33, s96, v33
    s_lshl_b32 s96, s3, 9
    s_add_u32 s96, s96, 46592
    v_add_u32 v34, s96, v22
    v_and_b32 v35, 16, v1
    v_lshl_add_u32 v35, v35, 10, v21
    v_lshrrev_b32 v46, 3, v1
    v_lshlrev_b32 v45, 4, v45
    v_lshl_add_u32 v36, v46, 8, v45
    v_lshlrev_b32 v37, 4, v46
    s_mul_i32 s96, s95, 320
    s_add_u32 s96, s96, s77
    v_lshl_add_u32 v38, v3, 2, v45
    v_add_u32 v38, s96, v38
    s_and_b32 s96, s3, 3
    s_lshl_b32 s96, s96, 9
    s_add_u32 s96, s96, 30208
    v_lshrrev_b32 v46, 5, v1
    v_lshl_add_u32 v19, v46, 11, v22
    v_add_u32 v19, s96, v19
    v_and_b32 v45, 3, v1
    v_lshrrev_b32 v46, 2, v1
    v_lshlrev_b32 v40, 4, v45
    v_lshl_add_u32 v40, v46, 12, v40
    s_bfe_u32 s96, s2, 0x20004
    s_lshr_b32 s89, s2, 6
    s_lshl2_add_u32 s96, s96, s89
    s_and_b32 s89, s2, 15
    s_lshl4_add_u32 s96, s96, s89
    s_lshl_b32 s89, s96, 12
    s_add_u32 s89, s89, 5242880
Lskipdef_29:
    s_waitcnt vmcnt(5)
    buffer_load_dwordx4 v[72:75], v10, s[36:39], s73 offen offset:256 nt
    s_waitcnt vmcnt(5)
    buffer_load_dwordx4 v[76:79], v10, s[36:39], s73 offen offset:512 nt
    s_waitcnt vmcnt(5)
    buffer_load_dwordx4 v[80:83], v10, s[36:39], s73 offen offset:768 nt
    s_waitcnt vmcnt(5)
    s_waitcnt vmcnt(4)
    s_waitcnt vmcnt(2)
    s_barrier
    buffer_load_dwordx4 v[148:151], v20, s[60:63], s81 offen
    buffer_load_dwordx4 v[152:155], v20, s[60:63], s81 offen offset:1024
    buffer_load_dwordx4 v[156:159], v20, s[60:63], s81 offen offset:2048
    buffer_load_dwordx4 v[160:163], v20, s[60:63], s81 offen offset:3072
    s_barrier
    s_waitcnt vmcnt(3)
    v_perm_b32 v45, v149, v148, s70
    v_perm_b32 v46, v151, v150, s71
    v_or_b32 v45, v45, v46
    v_cmp_ne_u32 s[12:13], s69, v45
    s_waitcnt vmcnt(2)
    v_perm_b32 v45, v153, v152, s70
    v_perm_b32 v46, v155, v154, s71
    v_or_b32 v45, v45, v46
    v_cmp_ne_u32 s[14:15], s69, v45
    s_waitcnt vmcnt(1)
    v_perm_b32 v45, v157, v156, s70
    v_perm_b32 v46, v159, v158, s71
    v_or_b32 v45, v45, v46
    v_cmp_ne_u32 s[16:17], s69, v45
    s_waitcnt vmcnt(0)
    v_perm_b32 v45, v161, v160, s70
    v_perm_b32 v46, v163, v162, s71
    v_or_b32 v45, v45, v46
    v_cmp_ne_u32 s[18:19], s69, v45
    s_mov_b32 s94, 0
    s_or_b64 s[92:93], s[12:13], s[14:15]
    s_or_b64 s[92:93], s[92:93], s[16:17]
    s_or_b64 s[92:93], s[92:93], s[18:19]
    s_nop 0
    s_cbranch_scc0 Lok_30
Lre_31:
    s_add_u32 s94, s94, 1
    s_cmp_ge_u32 s94, 100000
    s_cbranch_scc1 Lok_30
    s_mov_b64 exec, s[12:13]
    s_cbranch_execz Lsk_32
    buffer_load_dwordx4 v[148:151], v20, s[60:63], s81 offen sc1
Lsk_32:
    s_mov_b64 exec, s[14:15]
    s_cbranch_execz Lsk_33
    buffer_load_dwordx4 v[152:155], v20, s[60:63], s81 offen offset:1024 sc1
Lsk_33:
    s_mov_b64 exec, s[16:17]
    s_cbranch_execz Lsk_34
    buffer_load_dwordx4 v[156:159], v20, s[60:63], s81 offen offset:2048 sc1
Lsk_34:
    s_mov_b64 exec, s[18:19]
    s_cbranch_execz Lsk_35
    buffer_load_dwordx4 v[160:163], v20, s[60:63], s81 offen offset:3072 sc1
Lsk_35:
    s_waitcnt vmcnt(0)
    s_mov_b64 exec, s[12:13]
    v_perm_b32 v45, v149, v148, s70
    v_perm_b32 v46, v151, v150, s71
    v_or_b32 v45, v45, v46
    v_cmp_ne_u32 s[12:13], s69, v45
    s_mov_b64 exec, s[14:15]
    v_perm_b32 v45, v153, v152, s70
    v_perm_b32 v46, v155, v154, s71
    v_or_b32 v45, v45, v46
    v_cmp_ne_u32 s[14:15], s69, v45
    s_mov_b64 exec, s[16:17]
    v_perm_b32 v45, v157, v156, s70
    v_perm_b32 v46, v159, v158, s71
    v_or_b32 v45, v45, v46
    v_cmp_ne_u32 s[16:17], s69, v45
    s_mov_b64 exec, s[18:19]
    v_perm_b32 v45, v161, v160, s70
    v_perm_b32 v46, v163, v162, s71
    v_or_b32 v45, v45, v46
    v_cmp_ne_u32 s[18:19], s69, v45
    s_mov_b64 exec, -1
    s_or_b64 s[92:93], s[12:13], s[14:15]
    s_or_b64 s[92:93], s[92:93], s[16:17]
    s_or_b64 s[92:93], s[92:93], s[18:19]
    s_nop 0
    s_cbranch_scc1 Lre_31
Lok_30:
    s_mov_b64 exec, -1
    v_and_b32 v148, 0xffffff00, v148
    v_and_b32 v149, 0xffffff00, v149
    v_and_b32 v150, 0xffffff00, v150
    v_and_b32 v151, 0xffffff00, v151
    v_and_b32 v152, 0xffffff00, v152
    v_and_b32 v153, 0xffffff00, v153
    v_and_b32 v154, 0xffffff00, v154
    v_and_b32 v155, 0xffffff00, v155
    v_and_b32 v156, 0xffffff00, v156
    v_and_b32 v157, 0xffffff00, v157
    v_and_b32 v158, 0xffffff00, v158
    v_and_b32 v159, 0xffffff00, v159
    v_and_b32 v160, 0xffffff00, v160
    v_and_b32 v161, 0xffffff00, v161
    v_and_b32 v162, 0xffffff00, v162
    v_and_b32 v163, 0xffffff00, v163
    v_pk_add_f32 v[148:149], v[148:149], v[152:153]
    v_pk_add_f32 v[156:157], v[156:157], v[160:161]
    v_pk_add_f32 v[150:151], v[150:151], v[154:155]
    v_pk_add_f32 v[158:159], v[158:159], v[162:163]
    v_pk_add_f32 v[148:149], v[148:149], v[156:157]
    v_pk_add_f32 v[150:151], v[150:151], v[158:159]
    s_nop 1
    v_permlane32_swap_b32 v148, v150
    v_add_f32 v148, v148, v150
    v_permlane32_swap_b32 v149, v151
    v_add_f32 v149, v149, v151
    v_cvt_pk_bf16_f32 v152, v148, v149
    ds_write_b32 v28, v152
    s_waitcnt lgkmcnt(0)
    s_barrier
    ds_read_b128 v[164:167], v23
    ds_read_b128 v[212:215], v27
    ds_read_b128 v[168:171], v24
    ds_read_b128 v[216:219], v27 offset:64
    ds_read_b128 v[172:175], v25
    ds_read_b128 v[220:223], v27 offset:128
    ds_read_b128 v[176:179], v26
    ds_read_b128 v[224:227], v27 offset:192
    s_waitcnt lgkmcnt(6)
    v_mfma_f32_16x16x32_bf16 v[228:231], v[164:167], v[212:215], 0
    s_waitcnt lgkmcnt(4)
    v_mfma_f32_16x16x32_bf16 v[228:231], v[168:171], v[216:219], v[228:231]
    s_waitcnt lgkmcnt(2)
    v_mfma_f32_16x16x32_bf16 v[228:231], v[172:175], v[220:223], v[228:231]
    s_waitcnt lgkmcnt(0)
    v_mfma_f32_16x16x32_bf16 v[228:231], v[176:179], v[224:227], v[228:231]
    s_nop 7
    v_cvt_pk_bf16_f32 v236, v228, v229
    v_cvt_pk_bf16_f32 v237, v230, v231
    v_lshlrev_b32 v232, 16, v236
    v_and_b32 v233, 0xffff0000, v236
    v_lshlrev_b32 v234, 16, v237
    v_and_b32 v235, 0xffff0000, v237
    v_mul_f32 v232, 0x3db504f3, v232
    v_mul_f32 v233, 0x3db504f3, v233
    v_mul_f32 v234, 0x3db504f3, v234
    v_mul_f32 v235, 0x3db504f3, v235
    v_cvt_pk_bf16_f32 v236, v232, v233
    v_cvt_pk_bf16_f32 v237, v234, v235
    v_lshlrev_b32 v232, 16, v236
    v_and_b32 v233, 0xffff0000, v236
    v_lshlrev_b32 v234, 16, v237
    v_and_b32 v235, 0xffff0000, v237
    v_max3_f32 v238, v232, v233, v234
    v_max_f32 v238, v238, v235
    v_mov_b32 v240, v238
    s_nop 1
    v_permlane16_swap_b32 v238, v240
    v_max_f32 v238, v238, v240
    v_mov_b32 v240, v238
    s_nop 1
    v_permlane32_swap_b32 v238, v240
    v_max_f32 v238, v238, v240
    v_sub_f32 v232, v232, v238
    v_sub_f32 v233, v233, v238
    v_sub_f32 v234, v234, v238
    v_sub_f32 v235, v235, v238
    v_mul_f32 v232, 0x3fb8aa3b, v232
    v_mul_f32 v233, 0x3fb8aa3b, v233
    v_mul_f32 v234, 0x3fb8aa3b, v234
    v_mul_f32 v235, 0x3fb8aa3b, v235
    v_exp_f32 v232, v232
    v_exp_f32 v233, v233
    v_exp_f32 v234, v234
    v_exp_f32 v235, v235
    v_cvt_pk_bf16_f32 v228, v232, v232
    v_cvt_pk_bf16_f32 v229, v233, v233
    v_cvt_pk_bf16_f32 v230, v234, v234
    v_cvt_pk_bf16_f32 v231, v235, v235
    ds_write_b128 v29, v[228:231] offset:5376
    ds_read_b128 v[204:207], v30 offset:5376
    ds_read_b128 v[208:211], v30 offset:5632
    v_add_f32 v239, v232, v233
    v_add_f32 v240, v234, v235
    v_add_f32 v239, v239, v240
    v_mov_b32 v240, v239
    s_nop 1
    v_permlane16_swap_b32 v239, v240
    v_add_f32 v239, v239, v240
    v_mov_b32 v240, v239
    s_nop 1
    v_permlane32_swap_b32 v239, v240
    v_add_f32 v239, v239, v240
    s_mov_b64 exec, 0xff
    ds_write_b64 v31, v[238:239] offset:2176
    s_mov_b64 exec, -1
    s_waitcnt lgkmcnt(1)
    v_and_b32 v212, v204, v4
    v_and_b32 v213, v204, v5
    v_and_b32 v214, v205, v4
    v_and_b32 v215, v205, v5
    v_and_b32 v216, v206, v4
    v_and_b32 v217, v206, v5
    v_and_b32 v218, v207, v4
    v_and_b32 v219, v207, v5
    v_and_b32 v220, v208, v4
    v_and_b32 v221, v208, v5
    v_and_b32 v222, v209, v4
    v_and_b32 v223, v209, v5
    v_and_b32 v224, v210, v4
    v_and_b32 v225, v210, v5
    v_and_b32 v226, v211, v4
    v_and_b32 v227, v211, v5
    v_mfma_f32_16x16x16_bf16 v[180:183], v[212:213], v[68:69], 0
    v_mfma_f32_16x16x16_bf16 v[184:187], v[212:213], v[70:71], 0
    v_mfma_f32_16x16x16_bf16 v[188:191], v[220:221], v[68:69], 0
    v_mfma_f32_16x16x16_bf16 v[192:195], v[220:221], v[70:71], 0
    v_mfma_f32_16x16x16_bf16 v[180:183], v[214:215], v[72:73], v[180:183]
    v_mfma_f32_16x16x16_bf16 v[184:187], v[214:215], v[74:75], v[184:187]
    v_mfma_f32_16x16x16_bf16 v[188:191], v[222:223], v[72:73], v[188:191]
    v_mfma_f32_16x16x16_bf16 v[192:195], v[222:223], v[74:75], v[192:195]
    s_waitcnt vmcnt(5)
    v_mfma_f32_16x16x16_bf16 v[180:183], v[216:217], v[76:77], v[180:183]
    v_mfma_f32_16x16x16_bf16 v[184:187], v[216:217], v[78:79], v[184:187]
    v_mfma_f32_16x16x16_bf16 v[188:191], v[224:225], v[76:77], v[188:191]
    v_mfma_f32_16x16x16_bf16 v[192:195], v[224:225], v[78:79], v[192:195]
    s_waitcnt vmcnt(4)
    v_mfma_f32_16x16x16_bf16 v[180:183], v[218:219], v[80:81], v[180:183]
    v_mfma_f32_16x16x16_bf16 v[184:187], v[218:219], v[82:83], v[184:187]
    v_mfma_f32_16x16x16_bf16 v[188:191], v[226:227], v[80:81], v[188:191]
    v_mfma_f32_16x16x16_bf16 v[192:195], v[226:227], v[82:83], v[192:195]
    s_nop 4
    ds_write_b128 v32, v[180:183]
    ds_write_b128 v32, v[184:187] offset:16
    ds_write_b128 v32, v[188:191] offset:2048
    ds_write_b128 v32, v[192:195] offset:2064
    s_waitcnt lgkmcnt(0)
    s_barrier
    ds_read_b64 v[236:237], v33 offset:2176
    ds_read_b128 v[148:151], v34
    ds_read_b128 v[152:155], v34 offset:4096
    ds_read_b128 v[156:159], v34 offset:8192
    ds_read_b128 v[160:163], v34 offset:12288
    ds_read_b128 v[164:167], v34 offset:16384
    ds_read_b128 v[168:171], v34 offset:20480
    ds_read_b128 v[172:175], v34 offset:24576
    ds_read_b128 v[176:179], v34 offset:28672
    s_waitcnt lgkmcnt(8)
    v_mov_b32 v232, v236
    s_nop 1
    v_max_f32_dpp v232, v232, v232 quad_perm:[1,0,3,2] row_mask:0xf bank_mask:0xf
    s_nop 1
    v_max_f32_dpp v232, v232, v232 quad_perm:[2,3,0,1] row_mask:0xf bank_mask:0xf
    s_nop 1
    v_max_f32_dpp v232, v232, v232 row_half_mirror row_mask:0xf bank_mask:0xf
    v_sub_f32 v236, v236, v232
    v_mul_f32 v236, 0x3fb8aa3b, v236
    v_exp_f32 v236, v236
    s_nop 0
    v_mul_f32 v233, v236, v237
    v_readlane_b32 s4, v236, 0
    v_readlane_b32 s5, v236, 1
    v_readlane_b32 s6, v236, 2
    v_readlane_b32 s7, v236, 3
    v_readlane_b32 s8, v236, 4
    v_readlane_b32 s9, v236, 5
    v_readlane_b32 s10, v236, 6
    v_readlane_b32 s11, v236, 7
    v_add_f32_dpp v233, v233, v233 quad_perm:[1,0,3,2] row_mask:0xf bank_mask:0xf
    s_nop 1
    v_add_f32_dpp v233, v233, v233 quad_perm:[2,3,0,1] row_mask:0xf bank_mask:0xf
    s_nop 1
    v_add_f32_dpp v233, v233, v233 row_half_mirror row_mask:0xf bank_mask:0xf
    v_mov_b32 v234, 0
    v_mov_b32 v235, 0
    s_waitcnt lgkmcnt(7)
    v_pk_mul_f32 v[228:229], v[148:149], s[4:5] op_sel_hi:[1,0]
    v_pk_mul_f32 v[230:231], v[150:151], s[4:5] op_sel_hi:[1,0]
    s_waitcnt lgkmcnt(6)
    v_pk_fma_f32 v[228:229], v[152:153], s[4:5], v[228:229] op_sel:[0,1,0] op_sel_hi:[1,1,1]
    v_pk_fma_f32 v[230:231], v[154:155], s[4:5], v[230:231] op_sel:[0,1,0] op_sel_hi:[1,1,1]
    s_waitcnt lgkmcnt(5)
    v_pk_fma_f32 v[228:229], v[156:157], s[6:7], v[228:229] op_sel_hi:[1,0,1]
    v_pk_fma_f32 v[230:231], v[158:159], s[6:7], v[230:231] op_sel_hi:[1,0,1]
    s_waitcnt lgkmcnt(4)
    v_pk_fma_f32 v[228:229], v[160:161], s[6:7], v[228:229] op_sel:[0,1,0] op_sel_hi:[1,1,1]
    v_pk_fma_f32 v[230:231], v[162:163], s[6:7], v[230:231] op_sel:[0,1,0] op_sel_hi:[1,1,1]
    s_waitcnt lgkmcnt(3)
    v_pk_fma_f32 v[228:229], v[164:165], s[8:9], v[228:229] op_sel_hi:[1,0,1]
    v_pk_fma_f32 v[230:231], v[166:167], s[8:9], v[230:231] op_sel_hi:[1,0,1]
    s_waitcnt lgkmcnt(2)
    v_pk_fma_f32 v[228:229], v[168:169], s[8:9], v[228:229] op_sel:[0,1,0] op_sel_hi:[1,1,1]
    v_pk_fma_f32 v[230:231], v[170:171], s[8:9], v[230:231] op_sel:[0,1,0] op_sel_hi:[1,1,1]
    s_waitcnt lgkmcnt(1)
    v_pk_fma_f32 v[228:229], v[172:173], s[10:11], v[228:229] op_sel_hi:[1,0,1]
    v_pk_fma_f32 v[230:231], v[174:175], s[10:11], v[230:231] op_sel_hi:[1,0,1]
    s_waitcnt lgkmcnt(0)
    v_pk_fma_f32 v[228:229], v[176:177], s[10:11], v[228:229] op_sel:[0,1,0] op_sel_hi:[1,1,1]
    v_pk_fma_f32 v[230:231], v[178:179], s[10:11], v[230:231] op_sel:[0,1,0] op_sel_hi:[1,1,1]
    v_add_u32 v232, 0x80, v232
    v_add_u32 v233, 0x80, v233
    v_add_u32 v234, 0x80, v234
    v_add_u32 v235, 0x80, v235
    v_bfi_b32 v232, v6, s65, v232
    v_bfi_b32 v233, v6, s66, v233
    v_bfi_b32 v234, v6, s67, v234
    v_bfi_b32 v235, v6, s68, v235
    v_add_u32 v228, 0x80, v228
    v_add_u32 v229, 0x80, v229
    v_add_u32 v230, 0x80, v230
    v_add_u32 v231, 0x80, v231
    v_bfi_b32 v228, v6, s65, v228
    v_bfi_b32 v229, v6, s66, v229
    v_bfi_b32 v230, v6, s67, v230
    v_bfi_b32 v231, v6, s68, v231
    s_mov_b32 exec_hi, 0
    buffer_store_dwordx4 v[228:231], v35, s[60:63], s82 offen sc1
    s_mov_b64 exec, 1
    buffer_store_dwordx4 v[232:235], off, s[60:63], s83 sc1
    s_mov_b64 exec, -1
    buffer_load_dwordx4 v[116:119], v9, s[44:47], s75 offen nt
    s_waitcnt vmcnt(0)
    buffer_load_dwordx4 v[120:123], v9, s[44:47], s75 offen offset:2048 nt
    s_waitcnt vmcnt(0)
    s_add_u32 s96, s75, 4096
    buffer_load_dwordx4 v[124:127], v9, s[44:47], s96 offen nt
    s_waitcnt vmcnt(0)
    s_add_u32 s96, s75, 6144
    buffer_load_dwordx4 v[128:131], v9, s[44:47], s96 offen nt
    s_waitcnt vmcnt(0)
    s_barrier
    buffer_load_dwordx4 v[156:159], v37, s[60:63], s86 offen
    buffer_load_dwordx4 v[160:163], v37, s[60:63], s86 offen offset:128
    buffer_load_dwordx4 v[148:151], v36, s[60:63], s85 offen
    buffer_load_dwordx4 v[152:155], v36, s[60:63], s85 offen offset:2048
    s_barrier
    s_waitcnt vmcnt(3)
    v_perm_b32 v45, v157, v156, s70
    v_perm_b32 v46, v159, v158, s71
    v_or_b32 v45, v45, v46
    v_cmp_ne_u32 s[12:13], s69, v45
    s_waitcnt vmcnt(2)
    v_perm_b32 v45, v161, v160, s70
    v_perm_b32 v46, v163, v162, s71
    v_or_b32 v45, v45, v46
    v_cmp_ne_u32 s[14:15], s69, v45
    s_waitcnt vmcnt(1)
    v_perm_b32 v45, v149, v148, s70
    v_perm_b32 v46, v151, v150, s71
    v_or_b32 v45, v45, v46
    v_cmp_ne_u32 s[16:17], s69, v45
    s_waitcnt vmcnt(0)
    v_perm_b32 v45, v153, v152, s70
    v_perm_b32 v46, v155, v154, s71
    v_or_b32 v45, v45, v46
    v_cmp_ne_u32 s[18:19], s69, v45
    s_mov_b32 s94, 0
    s_or_b64 s[92:93], s[12:13], s[14:15]
    s_or_b64 s[92:93], s[92:93], s[16:17]
    s_or_b64 s[92:93], s[92:93], s[18:19]
    s_nop 0
    s_cbranch_scc0 Lok_36
Lre_37:
    s_add_u32 s94, s94, 1
    s_cmp_ge_u32 s94, 100000
    s_cbranch_scc1 Lok_36
    s_sleep 16
    s_mov_b64 exec, s[12:13]
    s_cbranch_execz Lsk_38
    buffer_load_dwordx4 v[156:159], v37, s[60:63], s86 offen sc1
Lsk_38:
    s_mov_b64 exec, s[14:15]
    s_cbranch_execz Lsk_39
    buffer_load_dwordx4 v[160:163], v37, s[60:63], s86 offen offset:128 sc1
Lsk_39:
    s_mov_b64 exec, s[16:17]
    s_cbranch_execz Lsk_40
    buffer_load_dwordx4 v[148:151], v36, s[60:63], s85 offen sc1
Lsk_40:
    s_mov_b64 exec, s[18:19]
    s_cbranch_execz Lsk_41
    buffer_load_dwordx4 v[152:155], v36, s[60:63], s85 offen offset:2048 sc1
Lsk_41:
    s_waitcnt vmcnt(0)
    s_mov_b64 exec, s[12:13]
    v_perm_b32 v45, v157, v156, s70
    v_perm_b32 v46, v159, v158, s71
    v_or_b32 v45, v45, v46
    v_cmp_ne_u32 s[12:13], s69, v45
    s_mov_b64 exec, s[14:15]
    v_perm_b32 v45, v161, v160, s70
    v_perm_b32 v46, v163, v162, s71
    v_or_b32 v45, v45, v46
    v_cmp_ne_u32 s[14:15], s69, v45
    s_mov_b64 exec, s[16:17]
    v_perm_b32 v45, v149, v148, s70
    v_perm_b32 v46, v151, v150, s71
    v_or_b32 v45, v45, v46
    v_cmp_ne_u32 s[16:17], s69, v45
    s_mov_b64 exec, s[18:19]
    v_perm_b32 v45, v153, v152, s70
    v_perm_b32 v46, v155, v154, s71
    v_or_b32 v45, v45, v46
    v_cmp_ne_u32 s[18:19], s69, v45
    s_mov_b64 exec, -1
    s_or_b64 s[92:93], s[12:13], s[14:15]
    s_or_b64 s[92:93], s[92:93], s[16:17]
    s_or_b64 s[92:93], s[92:93], s[18:19]
    s_nop 0
    s_cbranch_scc1 Lre_37
Lok_36:
    s_mov_b64 exec, -1
    v_and_b32 v156, 0xffffff00, v156
    v_and_b32 v157, 0xffffff00, v157
    v_and_b32 v160, 0xffffff00, v160
    v_and_b32 v161, 0xffffff00, v161
    v_and_b32 v148, 0xffffff00, v148
    v_and_b32 v149, 0xffffff00, v149
    v_and_b32 v150, 0xffffff00, v150
    v_and_b32 v151, 0xffffff00, v151
    v_and_b32 v152, 0xffffff00, v152
    v_and_b32 v153, 0xffffff00, v153
    v_and_b32 v154, 0xffffff00, v154
    v_and_b32 v155, 0xffffff00, v155
    v_max_f32 v232, v156, v160
    s_nop 1
    v_max_f32_dpp v232, v232, v232 row_ror:8 row_mask:0xf bank_mask:0xf
    v_mov_b32 v233, v232
    s_nop 1
    v_permlane16_swap_b32 v232, v233
    v_max_f32 v232, v232, v233
    v_mov_b32 v233, v232
    s_nop 1
    v_permlane32_swap_b32 v232, v233
    v_max_f32 v232, v232, v233
    v_sub_f32 v156, v156, v232
    v_sub_f32 v160, v160, v232
    v_mul_f32 v156, 0x3fb8aa3b, v156
    v_mul_f32 v160, 0x3fb8aa3b, v160
    v_exp_f32 v156, v156
    v_exp_f32 v160, v160
    v_mul_f32 v232, v156, v157
    v_pk_mul_f32 v[228:229], v[148:149], v[156:157] op_sel_hi:[1,0]
    v_pk_mul_f32 v[230:231], v[150:151], v[156:157] op_sel_hi:[1,0]
    v_fmac_f32 v232, v160, v161
    v_pk_fma_f32 v[228:229], v[152:153], v[160:161], v[228:229] op_sel_hi:[1,0,1]
    v_pk_fma_f32 v[230:231], v[154:155], v[160:161], v[230:231] op_sel_hi:[1,0,1]
    v_add_f32_dpp v232, v232, v232 row_ror:8 row_mask:0xf bank_mask:0xf
    v_mov_b32 v233, v232
    s_nop 1
    v_permlane16_swap_b32 v232, v233
    v_add_f32 v232, v232, v233
    v_mov_b32 v233, v232
    s_nop 1
    v_permlane32_swap_b32 v232, v233
    v_add_f32 v232, v232, v233
    v_permlane32_swap_b32 v228, v230
    v_add_f32 v228, v228, v230
    v_permlane32_swap_b32 v229, v231
    v_add_f32 v229, v229, v231
    v_rcp_f32 v232, v232
    s_nop 0
    v_permlane16_swap_b32 v228, v229
    v_add_f32 v228, v228, v229
    s_nop 1
    v_add_f32_dpp v228, v228, v228 row_ror:8 row_mask:0xf bank_mask:0xf
    v_mul_f32 v228, v228, v232
    v_cvt_pk_bf16_f32 v228, v228, v228
    ds_write_b32 v38, v228 offset:2688
    s_waitcnt lgkmcnt(0)
    s_barrier
    ds_read_b128 v[204:207], v39 offset:2688
    s_waitcnt lgkmcnt(0)
    v_and_b32 v212, v204, v4
    v_and_b32 v213, v204, v5
    v_and_b32 v214, v205, v4
    v_and_b32 v215, v205, v5
    v_and_b32 v216, v206, v4
    v_and_b32 v217, v206, v5
    v_and_b32 v218, v207, v4
    v_and_b32 v219, v207, v5
    s_waitcnt vmcnt(7)
    v_mfma_f32_16x16x16_bf16 v[180:183], v[212:213], v[116:117], 0
    v_mfma_f32_16x16x16_bf16 v[184:187], v[212:213], v[118:119], 0
    s_waitcnt vmcnt(6)
    v_mfma_f32_16x16x16_bf16 v[180:183], v[214:215], v[120:121], v[180:183]
    v_mfma_f32_16x16x16_bf16 v[184:187], v[214:215], v[122:123], v[184:187]
    s_waitcnt vmcnt(5)
    v_mfma_f32_16x16x16_bf16 v[180:183], v[216:217], v[124:125], v[180:183]
    v_mfma_f32_16x16x16_bf16 v[184:187], v[216:217], v[126:127], v[184:187]
    s_waitcnt vmcnt(4)
    v_mfma_f32_16x16x16_bf16 v[180:183], v[218:219], v[128:129], v[180:183]
    v_mfma_f32_16x16x16_bf16 v[184:187], v[218:219], v[130:131], v[184:187]
    s_nop 6
    ds_write_b128 v17, v[180:183]
    ds_write_b128 v17, v[184:187] offset:16
    s_waitcnt lgkmcnt(0)
    s_barrier
    s_cmp_lt_u32 s3, 4
    s_cbranch_scc1 Lx_43
    ds_read_b128 v[148:151], v19
    ds_read_b128 v[152:155], v19 offset:4096
    ds_read_b128 v[156:159], v19 offset:8192
    ds_read_b128 v[160:163], v19 offset:12288
    s_waitcnt lgkmcnt(2)
    v_pk_add_f32 v[148:149], v[148:149], v[152:153]
    v_pk_add_f32 v[150:151], v[150:151], v[154:155]
    s_waitcnt lgkmcnt(0)
    v_pk_add_f32 v[156:157], v[156:157], v[160:161]
    v_pk_add_f32 v[158:159], v[158:159], v[162:163]
    v_pk_add_f32 v[228:229], v[148:149], v[156:157]
    v_pk_add_f32 v[230:231], v[150:151], v[158:159]
    v_add_u32 v228, 0x80, v228
    v_add_u32 v229, 0x80, v229
    v_add_u32 v230, 0x80, v230
    v_add_u32 v231, 0x80, v231
    v_bfi_b32 v228, v6, s65, v228
    v_bfi_b32 v229, v6, s66, v229
    v_bfi_b32 v230, v6, s67, v230
    v_bfi_b32 v231, v6, s68, v231
    buffer_store_dwordx4 v[228:231], v40, s[60:63], s88 offen sc1
    s_cmp_lg_u32 s3, 7
    s_nop 0
    s_cbranch_scc1 Lx_43
    s_waitcnt vmcnt(0)
    s_branch Lfin_42
Lx_43:
    s_endpgm
Lfin_42:
    buffer_load_dwordx4 v[148:151], v20, s[60:63], s89 offen sc1
    buffer_load_dwordx4 v[152:155], v20, s[60:63], s89 offen offset:1024 sc1
    buffer_load_dwordx4 v[156:159], v20, s[60:63], s89 offen offset:2048 sc1
    buffer_load_dwordx4 v[160:163], v20, s[60:63], s89 offen offset:3072 sc1
    s_waitcnt vmcnt(3)
    v_perm_b32 v45, v149, v148, s70
    v_perm_b32 v46, v151, v150, s71
    v_or_b32 v45, v45, v46
    v_cmp_ne_u32 s[12:13], s69, v45
    s_waitcnt vmcnt(2)
    v_perm_b32 v45, v153, v152, s70
    v_perm_b32 v46, v155, v154, s71
    v_or_b32 v45, v45, v46
    v_cmp_ne_u32 s[14:15], s69, v45
    s_waitcnt vmcnt(1)
    v_perm_b32 v45, v157, v156, s70
    v_perm_b32 v46, v159, v158, s71
    v_or_b32 v45, v45, v46
    v_cmp_ne_u32 s[16:17], s69, v45
    s_waitcnt vmcnt(0)
    v_perm_b32 v45, v161, v160, s70
    v_perm_b32 v46, v163, v162, s71
    v_or_b32 v45, v45, v46
    v_cmp_ne_u32 s[18:19], s69, v45
    s_mov_b32 s94, 0
    s_or_b64 s[92:93], s[12:13], s[14:15]
    s_or_b64 s[92:93], s[92:93], s[16:17]
    s_or_b64 s[92:93], s[92:93], s[18:19]
    s_nop 0
    s_cbranch_scc0 Lok_44
Lre_45:
    s_add_u32 s94, s94, 1
    s_cmp_ge_u32 s94, 100000
    s_cbranch_scc1 Lok_44
    s_mov_b64 exec, s[12:13]
    s_cbranch_execz Lsk_46
    buffer_load_dwordx4 v[148:151], v20, s[60:63], s89 offen sc1
Lsk_46:
    s_mov_b64 exec, s[14:15]
    s_cbranch_execz Lsk_47
    buffer_load_dwordx4 v[152:155], v20, s[60:63], s89 offen offset:1024 sc1
Lsk_47:
    s_mov_b64 exec, s[16:17]
    s_cbranch_execz Lsk_48
    buffer_load_dwordx4 v[156:159], v20, s[60:63], s89 offen offset:2048 sc1
Lsk_48:
    s_mov_b64 exec, s[18:19]
    s_cbranch_execz Lsk_49
    buffer_load_dwordx4 v[160:163], v20, s[60:63], s89 offen offset:3072 sc1
Lsk_49:
    s_waitcnt vmcnt(0)
    s_mov_b64 exec, s[12:13]
    v_perm_b32 v45, v149, v148, s70
    v_perm_b32 v46, v151, v150, s71
    v_or_b32 v45, v45, v46
    v_cmp_ne_u32 s[12:13], s69, v45
    s_mov_b64 exec, s[14:15]
    v_perm_b32 v45, v153, v152, s70
    v_perm_b32 v46, v155, v154, s71
    v_or_b32 v45, v45, v46
    v_cmp_ne_u32 s[14:15], s69, v45
    s_mov_b64 exec, s[16:17]
    v_perm_b32 v45, v157, v156, s70
    v_perm_b32 v46, v159, v158, s71
    v_or_b32 v45, v45, v46
    v_cmp_ne_u32 s[16:17], s69, v45
    s_mov_b64 exec, s[18:19]
    v_perm_b32 v45, v161, v160, s70
    v_perm_b32 v46, v163, v162, s71
    v_or_b32 v45, v45, v46
    v_cmp_ne_u32 s[18:19], s69, v45
    s_mov_b64 exec, -1
    s_or_b64 s[92:93], s[12:13], s[14:15]
    s_or_b64 s[92:93], s[92:93], s[16:17]
    s_or_b64 s[92:93], s[92:93], s[18:19]
    s_nop 0
    s_cbranch_scc1 Lre_45
Lok_44:
    s_mov_b64 exec, -1
    v_and_b32 v148, 0xffffff00, v148
    v_and_b32 v149, 0xffffff00, v149
    v_and_b32 v150, 0xffffff00, v150
    v_and_b32 v151, 0xffffff00, v151
    v_and_b32 v152, 0xffffff00, v152
    v_and_b32 v153, 0xffffff00, v153
    v_and_b32 v154, 0xffffff00, v154
    v_and_b32 v155, 0xffffff00, v155
    v_and_b32 v156, 0xffffff00, v156
    v_and_b32 v157, 0xffffff00, v157
    v_and_b32 v158, 0xffffff00, v158
    v_and_b32 v159, 0xffffff00, v159
    v_and_b32 v160, 0xffffff00, v160
    v_and_b32 v161, 0xffffff00, v161
    v_and_b32 v162, 0xffffff00, v162
    v_and_b32 v163, 0xffffff00, v163
    v_pk_add_f32 v[148:149], v[148:149], v[152:153]
    v_pk_add_f32 v[156:157], v[156:157], v[160:161]
    v_pk_add_f32 v[150:151], v[150:151], v[154:155]
    v_pk_add_f32 v[158:159], v[158:159], v[162:163]
    v_pk_add_f32 v[148:149], v[148:149], v[156:157]
    v_pk_add_f32 v[150:151], v[150:151], v[158:159]
    s_nop 1
    v_permlane32_swap_b32 v148, v150
    v_add_f32 v148, v148, v150
    v_permlane32_swap_b32 v149, v151
    v_add_f32 v149, v149, v151
    s_nop 1
    v_permlane16_swap_b32 v148, v149
    v_add_f32 v148, v148, v149
    v_lshlrev_b32 v44, 16, v44
    s_nop 0
    v_add_f32_dpp v148, v148, v148 row_ror:4 row_mask:0xf bank_mask:0xf
    s_nop 1
    v_add_f32_dpp v148, v148, v148 row_ror:8 row_mask:0xf bank_mask:0xf
    v_add_f32 v148, v148, v44
    v_cvt_pk_bf16_f32 v148, v148, v148
    s_mov_b32 exec_lo, 0x000f000f
    s_mov_b32 exec_hi, 0x000f000f
    buffer_store_short v148, v41, s[56:59], s90 offen
    s_mov_b64 exec, -1
    s_endpgm
L_end:
    s_endpgm
L_codeend:
.section .rodata,"a"
.p2align 6
.amdhsa_kernel parallel_sum__sliding_block_cached__glu_gated_bilinear__decode_kernel
  .amdhsa_next_free_vgpr 256
  .amdhsa_next_free_sgpr 102
  .amdhsa_accum_offset 256
  .amdhsa_group_segment_fixed_size 0
  .amdhsa_kernarg_size 96
  .amdhsa_user_sgpr_count 2
  .amdhsa_user_sgpr_kernarg_segment_ptr 1
  .amdhsa_system_sgpr_workgroup_id_x 1
.end_amdhsa_kernel
```
